```python
import torch

def _softmax(x, axis=-1):
    return torch.softmax(x, dim=axis)
def _gelu(x):
    return torch.nn.functional.gelu(x, approximate="tanh")
def _silu(x):
    return torch.nn.functional.silu(x)
def _sigmoid(x):
    return torch.sigmoid(x)
def _layernorm(x, axis=-1, eps=1e-5):
    m = x.mean(dim=axis, keepdim=True)
    v = x.var(dim=axis, keepdim=True, unbiased=False)
    return (x - m) / torch.sqrt(v + eps)
def _scatter_add(tgt, idx, src, axis=0):
    return tgt.clone().index_add_(axis, idx, src)
def _segment_sum(src, seg, n):
    out = torch.zeros((n,) + src.shape[1:], dtype=src.dtype)
    return out.index_add_(0, seg, src)
def _pad(x, pw):
    flat = tuple(v for pair in reversed(pw) for v in pair)
    return torch.nn.functional.pad(x, flat)

kernel_name = 'sequential_preLN__sliding_block__glu_gated_bilinear__prompt'

def setup_inputs():

    _w = (lambda a: (lambda t: t.to(torch.bfloat16) if t.is_floating_point() else t)(torch.as_tensor(a)))
    def _A_setup():
        B, S, D = 1, 2048, 512
        return {
            "x": _w((lambda *s: torch.randn(*s, dtype=torch.bfloat16) * 0.05)(B, S, D)),
            "wqkv": _w((lambda *s: torch.randn(*s, dtype=torch.bfloat16) * 0.05)(D, 3 * D)),
            "wo": _w((lambda *s: torch.randn(*s, dtype=torch.bfloat16) * 0.05)(D, D)),
        }
    _A_in = _A_setup()

    def _B_setup():
        B, S, D, F = 1, 2048, 512, 1792
        return {
            "x": _w((lambda *s: torch.randn(*s, dtype=torch.bfloat16) * 0.05)(B, S, D)),
            "w_gate": _w((lambda *s: torch.randn(*s, dtype=torch.bfloat16) * 0.8)(D, F) * (D ** -0.5)),
            "w_up": _w((lambda *s: torch.randn(*s, dtype=torch.bfloat16) * 0.8)(D, F) * (D ** -0.5)),
            "w_down": _w((lambda *s: torch.randn(*s, dtype=torch.bfloat16) * 0.8)(F, D) * (F ** -0.5)),
        }
    _B_in = _B_setup()

    return {
        "A_x": _A_in["x"],
        "A_wqkv": _A_in["wqkv"],
        "A_wo": _A_in["wo"],
        "B_x": _B_in["x"],
        "B_w_gate": _B_in["w_gate"],
        "B_w_up": _B_in["w_up"],
        "B_w_down": _B_in["w_down"],
    }

def reference(A_x, A_wqkv, A_wo, B_x, B_w_gate, B_w_up, B_w_down):
    def _A_ref(x, wqkv, wo):
        B, S, D = x.shape
        H = 32; Dh = D // H; W = 256
        qkv = (lambda x, *d: x.permute(*d))((x @ wqkv).reshape(B, S, 3, H, Dh), 2, 0, 3, 1, 4)
        q, k, v = qkv[0], qkv[1], qkv[2]
        scores = torch.einsum("bhqd,bhkd->bhqk", q, k) * (Dh ** -0.5)
        idx = torch.arange(S)
        mask = (idx[:, None] - idx[None, :] >= 0) & (idx[:, None] - idx[None, :] < W)
        scores = torch.where(mask[None, None], scores, -1e9)
        p = _softmax(scores, axis=-1)
        o = torch.einsum("bhqk,bhkd->bhqd", p, v)
        return (lambda x, *d: x.permute(*d))(o, 0, 2, 1, 3).reshape(B, S, D) @ wo

    def _B_ref(x, w_gate, w_up, w_down):
        g = torch.einsum("bsd,df->bsf", x, w_gate)
        u = torch.einsum("bsd,df->bsf", x, w_up)
        h = g * u
        return torch.einsum("bsf,fd->bsd", h, w_down)

    x = A_x
    h = x + _A_ref(_layernorm(x, axis=-1), A_wqkv, A_wo)
    h2 = h + _B_ref(_layernorm(h, axis=-1), B_w_gate, B_w_up, B_w_down)
    return h2
```

```asm
; @launch grid=(256,1,1) block=(256,1,1) lds=163840
.amdgcn_target "amdgcn-amd-amdhsa--gfx950"
.text
.globl sequential_preLN__sliding_block__glu_gated_bilinear__prompt_kernel
.p2align 8
.type sequential_preLN__sliding_block__glu_gated_bilinear__prompt_kernel,@function
sequential_preLN__sliding_block__glu_gated_bilinear__prompt_kernel:
    s_load_dwordx2 s[24:25], s[0:1], 0
    s_load_dwordx2 s[28:29], s[0:1], 8
    s_load_dwordx2 s[32:33], s[0:1], 16
    s_cmp_ge_u32 s2, 256
    s_cbranch_scc1 L_exit
    s_getpc_b64 s[60:61]
    s_lshr_b32 s5, s2, 3
    v_min_u32 v51, 9, v0
    s_mul_i32 s62, s5, 1280
    v_lshl_add_u32 v51, v51, 7, s62
    v_lshrrev_b32 v50, 6, v0
    global_load_dword v49, v51, s[60:61]
    v_readfirstlane_b32 s3, v50
    v_and_b32 v0, 63, v0
    s_and_b32 s4, s2, 7
    s_and_b32 s6, s5, 3
    s_lshr_b32 s7, s5, 2
    s_xor_b32 s7, s7, 4
    s_lshl2_add_u32 s8, s4, s6
    s_lshl2_add_u32 s62, s8, s3
    s_lshl_b32 s62, s62, 14
    s_lshl_b32 s94, s7, 7
    s_or_b32 s62, s62, s94
    v_lshrrev_b32 v50, 3, v0
    v_and_b32 v51, 7, v0
    v_lshlrev_b32 v52, 10, v50
    v_lshl_add_u32 v54, v51, 4, v52
    v_add_u32 v55, 8192, v54
    s_mov_b32 s26, 2097152
    s_mov_b32 s27, 0x20000
    s_lshl2_add_u32 s95, s2, s3
    v_lshlrev_b32 v59, 7, v0
    s_waitcnt lgkmcnt(0)
    s_xor_b32 s70, s62, 0
    buffer_load_dwordx4 v[68:71], v54, s[24:27], s70 offen
    buffer_load_dwordx4 v[76:79], v55, s[24:27], s70 offen
    s_xor_b32 s70, s62, 128
    buffer_load_dwordx4 v[84:87], v54, s[24:27], s70 offen
    buffer_load_dwordx4 v[92:95], v55, s[24:27], s70 offen
    s_xor_b32 s70, s62, 256
    buffer_load_dwordx4 v[100:103], v54, s[24:27], s70 offen
    buffer_load_dwordx4 v[108:111], v55, s[24:27], s70 offen
    s_xor_b32 s70, s62, 384
    buffer_load_dwordx4 v[116:119], v54, s[24:27], s70 offen
    buffer_load_dwordx4 v[124:127], v55, s[24:27], s70 offen
    s_xor_b32 s70, s62, 512
    buffer_load_dwordx4 v[132:135], v54, s[24:27], s70 offen
    buffer_load_dwordx4 v[140:143], v55, s[24:27], s70 offen
    s_load_dwordx2 s[60:61], s[0:1], 72
    s_load_dwordx4 s[52:55], s[0:1], 32
    s_load_dwordx4 s[56:59], s[0:1], 48
    s_and_b32 s11, s3, 1
    s_lshr_b32 s12, s3, 1
    s_lshl_b32 s13, s3, 12
    s_lshl1_add_u32 s15, s6, s11
    s_mov_b32 s96, s4
    s_lshr_b32 s85, s96, 1
    s_mov_b32 s30, 1572864
    s_mov_b32 s31, 0x20000
    s_mov_b32 s34, 524288
    s_mov_b32 s35, 0x20000
    s_mov_b32 s42, 1835008
    s_mov_b32 s43, 0x20000
    s_mov_b32 s46, 2097152
    s_mov_b32 s47, 0x20000
    s_mov_b32 s50, 18874368
    s_mov_b32 s51, 0x20000
    s_mov_b32 s39, 0x20000
    v_lshlrev_b32 v1, 4, v0
    v_lshrrev_b32 v52, 2, v0
    v_and_b32 v52, 4, v52
    v_xor_b32 v52, v52, v51
    v_lshlrev_b32 v52, 4, v52
    v_mul_u32_u24 v53, 3072, v50
    v_add_u32 v2, v53, v52
    v_add_u32 v3, 23552, v2
    v_add_u32 v4, 47104, v2
    v_add_u32 v5, 70656, v2
    s_mul_i32 s64, s11, 98304
    s_lshl_b32 s63, s12, 10
    s_add_u32 s64, s64, s63
    s_add_u32 s64, s64, s94
    s_add_u32 s64, s64, 1024
    s_and_b32 s65, s96, 1
    s_lshl_b32 s65, s65, 1
    s_xor_b32 s65, s65, s3
    s_mul_i32 s65, s65, 98304
    s_add_u32 s65, s65, s94
    s_waitcnt lgkmcnt(0)
    s_load_dword s9, s[60:61], 0
    s_lshl_b32 s63, s4, 21
    s_add_u32 s48, s60, s63
    s_addc_u32 s49, s61, 0
    s_mov_b32 s40, s56
    s_mov_b32 s41, s57
    s_mov_b32 s44, s58
    s_mov_b32 s45, s59
    s_cmp_eq_u32 s12, 0
    s_cselect_b32 s36, s52, s54
    s_cselect_b32 s37, s53, s55
    s_cmp_lt_u32 s5, 28
    s_cselect_b32 s38, 1835008, 0
    v_lshlrev_b32 v53, 10, v50
    v_add_u32 v10, v53, v52
    s_lshl_b32 s63, s12, 5
    v_xor_b32 v52, s63, v52
    v_mul_u32_u24 v53, 3584, v50
    v_add_u32 v6, v53, v52
    s_mul_i32 s63, s3, 16640
    s_add_u32 s63, s63, 81920
    v_mul_u32_u24 v53, 1040, v50
    v_lshl_add_u32 v53, v51, 4, v53
    v_add_u32 v56, s63, v53
    s_xor_b32 s63, s94, 0
    v_add_u32 v200, s63, v56
    s_xor_b32 s63, s94, 128
    v_add_u32 v201, s63, v56
    s_xor_b32 s63, s94, 256
    v_add_u32 v202, s63, v56
    s_xor_b32 s63, s94, 384
    v_add_u32 v203, s63, v56
    s_xor_b32 s63, s94, 512
    v_add_u32 v204, s63, v56
    s_xor_b32 s63, s94, 640
    v_add_u32 v205, s63, v56
    s_xor_b32 s63, s94, 768
    v_add_u32 v206, s63, v56
    s_xor_b32 s63, s94, 896
    v_add_u32 v207, s63, v56
    v_and_b32 v50, 31, v0
    v_lshrrev_b32 v51, 5, v0
    s_mul_i32 s63, s11, 33280
    s_add_u32 s63, s63, 81920
    v_mul_u32_u24 v53, 1040, v50
    v_lshl_add_u32 v53, v51, 4, v53
    v_add_u32 v14, s63, v53
    v_bfe_u32 v57, v0, 2, 2
    v_and_b32 v50, 3, v0
    v_lshlrev_b32 v58, 3, v50
    v_and_b32 v50, 8, v0
    v_lshl_add_u32 v58, v50, 3, v58
    v_and_b32 v50, 16, v0
    v_lshl_add_u32 v58, v50, 1, v58
    s_lshl_b32 s63, s12, 6
    v_xor_b32 v52, s63, v58
    v_lshl_add_u32 v53, v51, 3, v57
    v_lshl_add_u32 v15, v53, 7, v52
    v_add_u32 v16, 0x10000, v15
    v_mov_b32 v192, 0
    v_mov_b32 v193, 0
    v_mov_b32 v194, 0
    v_mov_b32 v195, 0
    v_mov_b32 v196, 0
    v_mov_b32 v197, 0
    v_mov_b32 v198, 0
    v_mov_b32 v199, 0
    s_mov_b32 s66, 0xffff0000
    s_waitcnt vmcnt(9)
    s_xor_b32 s70, s62, 640
    buffer_load_dwordx4 v[148:151], v54, s[24:27], s70 offen
    buffer_load_dwordx4 v[156:159], v55, s[24:27], s70 offen
    v_lshlrev_b32 v64, 16, v68
    v_and_b32 v65, s66, v68
    v_pk_add_f32 v[192:193], v[192:193], v[64:65]
    v_pk_fma_f32 v[194:195], v[64:65], v[64:65], v[194:195]
    v_lshlrev_b32 v66, 16, v69
    v_and_b32 v67, s66, v69
    v_pk_add_f32 v[192:193], v[192:193], v[66:67]
    v_pk_fma_f32 v[194:195], v[66:67], v[66:67], v[194:195]
    v_lshlrev_b32 v68, 16, v70
    v_and_b32 v69, s66, v70
    v_pk_add_f32 v[192:193], v[192:193], v[68:69]
    v_pk_fma_f32 v[194:195], v[68:69], v[68:69], v[194:195]
    v_lshlrev_b32 v70, 16, v71
    v_and_b32 v71, s66, v71
    v_pk_add_f32 v[192:193], v[192:193], v[70:71]
    v_pk_fma_f32 v[194:195], v[70:71], v[70:71], v[194:195]
    s_waitcnt vmcnt(10)
    s_xor_b32 s70, s62, 768
    buffer_load_dwordx4 v[164:167], v54, s[24:27], s70 offen
    buffer_load_dwordx4 v[172:175], v55, s[24:27], s70 offen
    v_lshlrev_b32 v72, 16, v76
    v_and_b32 v73, s66, v76
    v_pk_add_f32 v[196:197], v[196:197], v[72:73]
    v_pk_fma_f32 v[198:199], v[72:73], v[72:73], v[198:199]
    v_lshlrev_b32 v74, 16, v77
    v_and_b32 v75, s66, v77
    v_pk_add_f32 v[196:197], v[196:197], v[74:75]
    v_pk_fma_f32 v[198:199], v[74:75], v[74:75], v[198:199]
    v_lshlrev_b32 v76, 16, v78
    v_and_b32 v77, s66, v78
    v_pk_add_f32 v[196:197], v[196:197], v[76:77]
    v_pk_fma_f32 v[198:199], v[76:77], v[76:77], v[198:199]
    v_lshlrev_b32 v78, 16, v79
    v_and_b32 v79, s66, v79
    v_pk_add_f32 v[196:197], v[196:197], v[78:79]
    v_pk_fma_f32 v[198:199], v[78:79], v[78:79], v[198:199]
    s_waitcnt vmcnt(11)
    s_xor_b32 s70, s62, 896
    buffer_load_dwordx4 v[180:183], v54, s[24:27], s70 offen
    buffer_load_dwordx4 v[188:191], v55, s[24:27], s70 offen
    v_lshlrev_b32 v80, 16, v84
    v_and_b32 v81, s66, v84
    v_pk_add_f32 v[192:193], v[192:193], v[80:81]
    v_pk_fma_f32 v[194:195], v[80:81], v[80:81], v[194:195]
    v_lshlrev_b32 v82, 16, v85
    v_and_b32 v83, s66, v85
    v_pk_add_f32 v[192:193], v[192:193], v[82:83]
    v_pk_fma_f32 v[194:195], v[82:83], v[82:83], v[194:195]
    v_lshlrev_b32 v84, 16, v86
    v_and_b32 v85, s66, v86
    v_pk_add_f32 v[192:193], v[192:193], v[84:85]
    v_pk_fma_f32 v[194:195], v[84:85], v[84:85], v[194:195]
    v_lshlrev_b32 v86, 16, v87
    v_and_b32 v87, s66, v87
    v_pk_add_f32 v[192:193], v[192:193], v[86:87]
    v_pk_fma_f32 v[194:195], v[86:87], v[86:87], v[194:195]
    s_waitcnt vmcnt(12)
    s_mul_i32 s63, s95, 1536
    v_add_u32 v208, s63, v59
    s_lshl_b32 s63, s95, 9
    v_add_u32 v209, s63, v59
    s_lshl2_add_u32 s61, s5, s3
    s_mul_i32 s63, s61, 12288
    s_sub_u32 s63, s63, 32384
    s_mov_b32 exec_lo, 0
    v_lshl_add_u32 v208, v0, 10, s63
    s_lshl_b32 s63, s61, 12
    s_sub_u32 s63, s63, 32384
    v_lshl_add_u32 v209, v0, 10, s63
    s_mov_b32 exec_lo, 0
    s_mov_b32 exec_hi, 4095
    global_load_dword v49, v208, s[28:29]
    s_mov_b32 exec_lo, 15
    s_mov_b32 exec_hi, 15
    global_load_dword v49, v209, s[32:33]
    s_mov_b64 exec, -1
    v_lshlrev_b32 v88, 16, v92
    v_and_b32 v89, s66, v92
    v_pk_add_f32 v[196:197], v[196:197], v[88:89]
    v_pk_fma_f32 v[198:199], v[88:89], v[88:89], v[198:199]
    v_lshlrev_b32 v90, 16, v93
    v_and_b32 v91, s66, v93
    v_pk_add_f32 v[196:197], v[196:197], v[90:91]
    v_pk_fma_f32 v[198:199], v[90:91], v[90:91], v[198:199]
    v_lshlrev_b32 v92, 16, v94
    v_and_b32 v93, s66, v94
    v_pk_add_f32 v[196:197], v[196:197], v[92:93]
    v_pk_fma_f32 v[198:199], v[92:93], v[92:93], v[198:199]
    v_lshlrev_b32 v94, 16, v95
    v_and_b32 v95, s66, v95
    v_pk_add_f32 v[196:197], v[196:197], v[94:95]
    v_pk_fma_f32 v[198:199], v[94:95], v[94:95], v[198:199]
    s_waitcnt vmcnt(13)
    s_add_u32 m0, s13, 0
    s_xor_b32 s91, s96, 0
    s_mul_i32 s91, s91, 196608
    s_add_u32 s91, s91, s64
    buffer_load_dwordx4 v2, s[28:31], s91 offen offset:0 lds
    v_lshlrev_b32 v96, 16, v100
    v_and_b32 v97, s66, v100
    v_pk_add_f32 v[192:193], v[192:193], v[96:97]
    v_pk_fma_f32 v[194:195], v[96:97], v[96:97], v[194:195]
    v_lshlrev_b32 v98, 16, v101
    v_and_b32 v99, s66, v101
    v_pk_add_f32 v[192:193], v[192:193], v[98:99]
    v_pk_fma_f32 v[194:195], v[98:99], v[98:99], v[194:195]
    v_lshlrev_b32 v100, 16, v102
    v_and_b32 v101, s66, v102
    v_pk_add_f32 v[192:193], v[192:193], v[100:101]
    v_pk_fma_f32 v[194:195], v[100:101], v[100:101], v[194:195]
    v_lshlrev_b32 v102, 16, v103
    v_and_b32 v103, s66, v103
    v_pk_add_f32 v[192:193], v[192:193], v[102:103]
    v_pk_fma_f32 v[194:195], v[102:103], v[102:103], v[194:195]
    s_waitcnt vmcnt(13)
    buffer_load_dwordx4 v3, s[28:31], s91 offen offset:1024 lds
    v_lshlrev_b32 v104, 16, v108
    v_and_b32 v105, s66, v108
    v_pk_add_f32 v[196:197], v[196:197], v[104:105]
    v_pk_fma_f32 v[198:199], v[104:105], v[104:105], v[198:199]
    v_lshlrev_b32 v106, 16, v109
    v_and_b32 v107, s66, v109
    v_pk_add_f32 v[196:197], v[196:197], v[106:107]
    v_pk_fma_f32 v[198:199], v[106:107], v[106:107], v[198:199]
    v_lshlrev_b32 v108, 16, v110
    v_and_b32 v109, s66, v110
    v_pk_add_f32 v[196:197], v[196:197], v[108:109]
    v_pk_fma_f32 v[198:199], v[108:109], v[108:109], v[198:199]
    v_lshlrev_b32 v110, 16, v111
    v_and_b32 v111, s66, v111
    v_pk_add_f32 v[196:197], v[196:197], v[110:111]
    v_pk_fma_f32 v[198:199], v[110:111], v[110:111], v[198:199]
    s_waitcnt vmcnt(13)
    buffer_load_dwordx4 v4, s[28:31], s91 offen offset:2048 lds
    v_lshlrev_b32 v112, 16, v116
    v_and_b32 v113, s66, v116
    v_pk_add_f32 v[192:193], v[192:193], v[112:113]
    v_pk_fma_f32 v[194:195], v[112:113], v[112:113], v[194:195]
    v_lshlrev_b32 v114, 16, v117
    v_and_b32 v115, s66, v117
    v_pk_add_f32 v[192:193], v[192:193], v[114:115]
    v_pk_fma_f32 v[194:195], v[114:115], v[114:115], v[194:195]
    v_lshlrev_b32 v116, 16, v118
    v_and_b32 v117, s66, v118
    v_pk_add_f32 v[192:193], v[192:193], v[116:117]
    v_pk_fma_f32 v[194:195], v[116:117], v[116:117], v[194:195]
    v_lshlrev_b32 v118, 16, v119
    v_and_b32 v119, s66, v119
    v_pk_add_f32 v[192:193], v[192:193], v[118:119]
    v_pk_fma_f32 v[194:195], v[118:119], v[118:119], v[194:195]
    s_waitcnt vmcnt(13)
    buffer_load_dwordx4 v5, s[28:31], s91 offen offset:3072 lds
    v_lshlrev_b32 v120, 16, v124
    v_and_b32 v121, s66, v124
    v_pk_add_f32 v[196:197], v[196:197], v[120:121]
    v_pk_fma_f32 v[198:199], v[120:121], v[120:121], v[198:199]
    v_lshlrev_b32 v122, 16, v125
    v_and_b32 v123, s66, v125
    v_pk_add_f32 v[196:197], v[196:197], v[122:123]
    v_pk_fma_f32 v[198:199], v[122:123], v[122:123], v[198:199]
    v_lshlrev_b32 v124, 16, v126
    v_and_b32 v125, s66, v126
    v_pk_add_f32 v[196:197], v[196:197], v[124:125]
    v_pk_fma_f32 v[198:199], v[124:125], v[124:125], v[198:199]
    v_lshlrev_b32 v126, 16, v127
    v_and_b32 v127, s66, v127
    v_pk_add_f32 v[196:197], v[196:197], v[126:127]
    v_pk_fma_f32 v[198:199], v[126:127], v[126:127], v[198:199]
    s_waitcnt vmcnt(13)
    s_add_u32 m0, s13, 16384
    s_xor_b32 s91, s96, 1
    s_mul_i32 s91, s91, 196608
    s_add_u32 s91, s91, s64
    buffer_load_dwordx4 v2, s[28:31], s91 offen offset:0 lds
    v_lshlrev_b32 v128, 16, v132
    v_and_b32 v129, s66, v132
    v_pk_add_f32 v[192:193], v[192:193], v[128:129]
    v_pk_fma_f32 v[194:195], v[128:129], v[128:129], v[194:195]
    v_lshlrev_b32 v130, 16, v133
    v_and_b32 v131, s66, v133
    v_pk_add_f32 v[192:193], v[192:193], v[130:131]
    v_pk_fma_f32 v[194:195], v[130:131], v[130:131], v[194:195]
    v_lshlrev_b32 v132, 16, v134
    v_and_b32 v133, s66, v134
    v_pk_add_f32 v[192:193], v[192:193], v[132:133]
    v_pk_fma_f32 v[194:195], v[132:133], v[132:133], v[194:195]
    v_lshlrev_b32 v134, 16, v135
    v_and_b32 v135, s66, v135
    v_pk_add_f32 v[192:193], v[192:193], v[134:135]
    v_pk_fma_f32 v[194:195], v[134:135], v[134:135], v[194:195]
    s_waitcnt vmcnt(13)
    buffer_load_dwordx4 v3, s[28:31], s91 offen offset:1024 lds
    v_lshlrev_b32 v136, 16, v140
    v_and_b32 v137, s66, v140
    v_pk_add_f32 v[196:197], v[196:197], v[136:137]
    v_pk_fma_f32 v[198:199], v[136:137], v[136:137], v[198:199]
    v_lshlrev_b32 v138, 16, v141
    v_and_b32 v139, s66, v141
    v_pk_add_f32 v[196:197], v[196:197], v[138:139]
    v_pk_fma_f32 v[198:199], v[138:139], v[138:139], v[198:199]
    v_lshlrev_b32 v140, 16, v142
    v_and_b32 v141, s66, v142
    v_pk_add_f32 v[196:197], v[196:197], v[140:141]
    v_pk_fma_f32 v[198:199], v[140:141], v[140:141], v[198:199]
    v_lshlrev_b32 v142, 16, v143
    v_and_b32 v143, s66, v143
    v_pk_add_f32 v[196:197], v[196:197], v[142:143]
    v_pk_fma_f32 v[198:199], v[142:143], v[142:143], v[198:199]
    s_waitcnt vmcnt(13)
    buffer_load_dwordx4 v4, s[28:31], s91 offen offset:2048 lds
    v_lshlrev_b32 v144, 16, v148
    v_and_b32 v145, s66, v148
    v_pk_add_f32 v[192:193], v[192:193], v[144:145]
    v_pk_fma_f32 v[194:195], v[144:145], v[144:145], v[194:195]
    v_lshlrev_b32 v146, 16, v149
    v_and_b32 v147, s66, v149
    v_pk_add_f32 v[192:193], v[192:193], v[146:147]
    v_pk_fma_f32 v[194:195], v[146:147], v[146:147], v[194:195]
    v_lshlrev_b32 v148, 16, v150
    v_and_b32 v149, s66, v150
    v_pk_add_f32 v[192:193], v[192:193], v[148:149]
    v_pk_fma_f32 v[194:195], v[148:149], v[148:149], v[194:195]
    v_lshlrev_b32 v150, 16, v151
    v_and_b32 v151, s66, v151
    v_pk_add_f32 v[192:193], v[192:193], v[150:151]
    v_pk_fma_f32 v[194:195], v[150:151], v[150:151], v[194:195]
    s_waitcnt vmcnt(13)
    buffer_load_dwordx4 v5, s[28:31], s91 offen offset:3072 lds
    v_lshlrev_b32 v152, 16, v156
    v_and_b32 v153, s66, v156
    v_pk_add_f32 v[196:197], v[196:197], v[152:153]
    v_pk_fma_f32 v[198:199], v[152:153], v[152:153], v[198:199]
    v_lshlrev_b32 v154, 16, v157
    v_and_b32 v155, s66, v157
    v_pk_add_f32 v[196:197], v[196:197], v[154:155]
    v_pk_fma_f32 v[198:199], v[154:155], v[154:155], v[198:199]
    v_lshlrev_b32 v156, 16, v158
    v_and_b32 v157, s66, v158
    v_pk_add_f32 v[196:197], v[196:197], v[156:157]
    v_pk_fma_f32 v[198:199], v[156:157], v[156:157], v[198:199]
    v_lshlrev_b32 v158, 16, v159
    v_and_b32 v159, s66, v159
    v_pk_add_f32 v[196:197], v[196:197], v[158:159]
    v_pk_fma_f32 v[198:199], v[158:159], v[158:159], v[198:199]
    s_waitcnt vmcnt(13)
    v_lshlrev_b32 v160, 16, v164
    v_and_b32 v161, s66, v164
    v_pk_add_f32 v[192:193], v[192:193], v[160:161]
    v_pk_fma_f32 v[194:195], v[160:161], v[160:161], v[194:195]
    v_lshlrev_b32 v162, 16, v165
    v_and_b32 v163, s66, v165
    v_pk_add_f32 v[192:193], v[192:193], v[162:163]
    v_pk_fma_f32 v[194:195], v[162:163], v[162:163], v[194:195]
    v_lshlrev_b32 v164, 16, v166
    v_and_b32 v165, s66, v166
    v_pk_add_f32 v[192:193], v[192:193], v[164:165]
    v_pk_fma_f32 v[194:195], v[164:165], v[164:165], v[194:195]
    v_lshlrev_b32 v166, 16, v167
    v_and_b32 v167, s66, v167
    v_pk_add_f32 v[192:193], v[192:193], v[166:167]
    v_pk_fma_f32 v[194:195], v[166:167], v[166:167], v[194:195]
    s_waitcnt vmcnt(12)
    v_lshlrev_b32 v168, 16, v172
    v_and_b32 v169, s66, v172
    v_pk_add_f32 v[196:197], v[196:197], v[168:169]
    v_pk_fma_f32 v[198:199], v[168:169], v[168:169], v[198:199]
    v_lshlrev_b32 v170, 16, v173
    v_and_b32 v171, s66, v173
    v_pk_add_f32 v[196:197], v[196:197], v[170:171]
    v_pk_fma_f32 v[198:199], v[170:171], v[170:171], v[198:199]
    v_lshlrev_b32 v172, 16, v174
    v_and_b32 v173, s66, v174
    v_pk_add_f32 v[196:197], v[196:197], v[172:173]
    v_pk_fma_f32 v[198:199], v[172:173], v[172:173], v[198:199]
    v_lshlrev_b32 v174, 16, v175
    v_and_b32 v175, s66, v175
    v_pk_add_f32 v[196:197], v[196:197], v[174:175]
    v_pk_fma_f32 v[198:199], v[174:175], v[174:175], v[198:199]
    s_waitcnt vmcnt(11)
    v_lshlrev_b32 v176, 16, v180
    v_and_b32 v177, s66, v180
    v_pk_add_f32 v[192:193], v[192:193], v[176:177]
    v_pk_fma_f32 v[194:195], v[176:177], v[176:177], v[194:195]
    v_lshlrev_b32 v178, 16, v181
    v_and_b32 v179, s66, v181
    v_pk_add_f32 v[192:193], v[192:193], v[178:179]
    v_pk_fma_f32 v[194:195], v[178:179], v[178:179], v[194:195]
    v_lshlrev_b32 v180, 16, v182
    v_and_b32 v181, s66, v182
    v_pk_add_f32 v[192:193], v[192:193], v[180:181]
    v_pk_fma_f32 v[194:195], v[180:181], v[180:181], v[194:195]
    v_lshlrev_b32 v182, 16, v183
    v_and_b32 v183, s66, v183
    v_pk_add_f32 v[192:193], v[192:193], v[182:183]
    v_pk_fma_f32 v[194:195], v[182:183], v[182:183], v[194:195]
    s_waitcnt vmcnt(10)
    v_lshlrev_b32 v184, 16, v188
    v_and_b32 v185, s66, v188
    v_pk_add_f32 v[196:197], v[196:197], v[184:185]
    v_pk_fma_f32 v[198:199], v[184:185], v[184:185], v[198:199]
    v_lshlrev_b32 v186, 16, v189
    v_and_b32 v187, s66, v189
    v_pk_add_f32 v[196:197], v[196:197], v[186:187]
    v_pk_fma_f32 v[198:199], v[186:187], v[186:187], v[198:199]
    v_lshlrev_b32 v188, 16, v190
    v_and_b32 v189, s66, v190
    v_pk_add_f32 v[196:197], v[196:197], v[188:189]
    v_pk_fma_f32 v[198:199], v[188:189], v[188:189], v[198:199]
    v_lshlrev_b32 v190, 16, v191
    v_and_b32 v191, s66, v191
    v_pk_add_f32 v[196:197], v[196:197], v[190:191]
    v_pk_fma_f32 v[198:199], v[190:191], v[190:191], v[198:199]
    v_add_f32 v192, v192, v193
    v_add_f32 v194, v194, v195
    v_add_f32 v196, v196, v197
    v_add_f32 v198, v198, v199
    v_add_f32_dpp v192, v192, v192 quad_perm:[1,0,3,2] row_mask:0xf bank_mask:0xf
    v_add_f32_dpp v194, v194, v194 quad_perm:[1,0,3,2] row_mask:0xf bank_mask:0xf
    v_add_f32_dpp v196, v196, v196 quad_perm:[1,0,3,2] row_mask:0xf bank_mask:0xf
    v_add_f32_dpp v198, v198, v198 quad_perm:[1,0,3,2] row_mask:0xf bank_mask:0xf
    v_add_f32_dpp v192, v192, v192 quad_perm:[2,3,0,1] row_mask:0xf bank_mask:0xf
    v_add_f32_dpp v194, v194, v194 quad_perm:[2,3,0,1] row_mask:0xf bank_mask:0xf
    v_add_f32_dpp v196, v196, v196 quad_perm:[2,3,0,1] row_mask:0xf bank_mask:0xf
    v_add_f32_dpp v198, v198, v198 quad_perm:[2,3,0,1] row_mask:0xf bank_mask:0xf
    v_add_f32_dpp v192, v192, v192 row_half_mirror row_mask:0xf bank_mask:0xf
    v_add_f32_dpp v194, v194, v194 row_half_mirror row_mask:0xf bank_mask:0xf
    v_add_f32_dpp v196, v196, v196 row_half_mirror row_mask:0xf bank_mask:0xf
    v_add_f32_dpp v198, v198, v198 row_half_mirror row_mask:0xf bank_mask:0xf
    s_mov_b32 s67, 0x3b000000
    s_mov_b32 s68, 0x3727c5ac
    v_mul_f32 v192, s67, v192
    v_mul_f32 v194, s67, v194
    v_mul_f32 v196, s67, v196
    v_mul_f32 v198, s67, v198
    v_fma_f32 v194, -v192, v192, v194
    v_fma_f32 v198, -v196, v196, v198
    v_max_f32 v194, 0, v194
    v_add_f32 v194, s68, v194
    v_max_f32 v198, 0, v198
    v_add_f32 v198, s68, v198
    v_rsq_f32 v194, v194
    v_rsq_f32 v198, v198
    v_mul_f32 v192, -v192, v194
    v_mul_f32 v196, -v196, v198
    s_waitcnt lgkmcnt(0)
    s_add_u32 s9, s9, 2654435760
    s_and_b32 s9, s9, 0xfffffff0
    s_getreg_b32 s14, hwreg(HW_REG_XCC_ID)
    s_and_b32 s14, s14, 15
    s_or_b32 s14, s14, s9
    v_mov_b32 v48, s9
    v_pk_fma_f32 v[64:65], v[64:65], v[194:195], v[192:193] op_sel_hi:[1,0,0]
    v_pk_fma_f32 v[66:67], v[66:67], v[194:195], v[192:193] op_sel_hi:[1,0,0]
    v_pk_fma_f32 v[68:69], v[68:69], v[194:195], v[192:193] op_sel_hi:[1,0,0]
    v_pk_fma_f32 v[70:71], v[70:71], v[194:195], v[192:193] op_sel_hi:[1,0,0]
    v_cvt_pk_bf16_f32 v64, v64, v65
    v_cvt_pk_bf16_f32 v65, v66, v67
    v_cvt_pk_bf16_f32 v66, v68, v69
    v_cvt_pk_bf16_f32 v67, v70, v71
    ds_write_b128 v200, v[64:67] offset:0
    v_pk_fma_f32 v[72:73], v[72:73], v[198:199], v[196:197] op_sel_hi:[1,0,0]
    v_pk_fma_f32 v[74:75], v[74:75], v[198:199], v[196:197] op_sel_hi:[1,0,0]
    v_pk_fma_f32 v[76:77], v[76:77], v[198:199], v[196:197] op_sel_hi:[1,0,0]
    v_pk_fma_f32 v[78:79], v[78:79], v[198:199], v[196:197] op_sel_hi:[1,0,0]
    v_cvt_pk_bf16_f32 v72, v72, v73
    v_cvt_pk_bf16_f32 v73, v74, v75
    v_cvt_pk_bf16_f32 v74, v76, v77
    v_cvt_pk_bf16_f32 v75, v78, v79
    ds_write_b128 v200, v[72:75] offset:8320
    v_pk_fma_f32 v[80:81], v[80:81], v[194:195], v[192:193] op_sel_hi:[1,0,0]
    v_pk_fma_f32 v[82:83], v[82:83], v[194:195], v[192:193] op_sel_hi:[1,0,0]
    v_pk_fma_f32 v[84:85], v[84:85], v[194:195], v[192:193] op_sel_hi:[1,0,0]
    v_pk_fma_f32 v[86:87], v[86:87], v[194:195], v[192:193] op_sel_hi:[1,0,0]
    v_cvt_pk_bf16_f32 v80, v80, v81
    v_cvt_pk_bf16_f32 v81, v82, v83
    v_cvt_pk_bf16_f32 v82, v84, v85
    v_cvt_pk_bf16_f32 v83, v86, v87
    ds_write_b128 v201, v[80:83] offset:0
    v_pk_fma_f32 v[88:89], v[88:89], v[198:199], v[196:197] op_sel_hi:[1,0,0]
    v_pk_fma_f32 v[90:91], v[90:91], v[198:199], v[196:197] op_sel_hi:[1,0,0]
    v_pk_fma_f32 v[92:93], v[92:93], v[198:199], v[196:197] op_sel_hi:[1,0,0]
    v_pk_fma_f32 v[94:95], v[94:95], v[198:199], v[196:197] op_sel_hi:[1,0,0]
    v_cvt_pk_bf16_f32 v88, v88, v89
    v_cvt_pk_bf16_f32 v89, v90, v91
    v_cvt_pk_bf16_f32 v90, v92, v93
    v_cvt_pk_bf16_f32 v91, v94, v95
    ds_write_b128 v201, v[88:91] offset:8320
    v_pk_fma_f32 v[96:97], v[96:97], v[194:195], v[192:193] op_sel_hi:[1,0,0]
    v_pk_fma_f32 v[98:99], v[98:99], v[194:195], v[192:193] op_sel_hi:[1,0,0]
    v_pk_fma_f32 v[100:101], v[100:101], v[194:195], v[192:193] op_sel_hi:[1,0,0]
    v_pk_fma_f32 v[102:103], v[102:103], v[194:195], v[192:193] op_sel_hi:[1,0,0]
    v_cvt_pk_bf16_f32 v96, v96, v97
    v_cvt_pk_bf16_f32 v97, v98, v99
    v_cvt_pk_bf16_f32 v98, v100, v101
    v_cvt_pk_bf16_f32 v99, v102, v103
    ds_write_b128 v202, v[96:99] offset:0
    v_pk_fma_f32 v[104:105], v[104:105], v[198:199], v[196:197] op_sel_hi:[1,0,0]
    v_pk_fma_f32 v[106:107], v[106:107], v[198:199], v[196:197] op_sel_hi:[1,0,0]
    v_pk_fma_f32 v[108:109], v[108:109], v[198:199], v[196:197] op_sel_hi:[1,0,0]
    v_pk_fma_f32 v[110:111], v[110:111], v[198:199], v[196:197] op_sel_hi:[1,0,0]
    v_cvt_pk_bf16_f32 v104, v104, v105
    v_cvt_pk_bf16_f32 v105, v106, v107
    v_cvt_pk_bf16_f32 v106, v108, v109
    v_cvt_pk_bf16_f32 v107, v110, v111
    ds_write_b128 v202, v[104:107] offset:8320
    v_pk_fma_f32 v[112:113], v[112:113], v[194:195], v[192:193] op_sel_hi:[1,0,0]
    v_pk_fma_f32 v[114:115], v[114:115], v[194:195], v[192:193] op_sel_hi:[1,0,0]
    v_pk_fma_f32 v[116:117], v[116:117], v[194:195], v[192:193] op_sel_hi:[1,0,0]
    v_pk_fma_f32 v[118:119], v[118:119], v[194:195], v[192:193] op_sel_hi:[1,0,0]
    v_cvt_pk_bf16_f32 v112, v112, v113
    v_cvt_pk_bf16_f32 v113, v114, v115
    v_cvt_pk_bf16_f32 v114, v116, v117
    v_cvt_pk_bf16_f32 v115, v118, v119
    ds_write_b128 v203, v[112:115] offset:0
    v_pk_fma_f32 v[120:121], v[120:121], v[198:199], v[196:197] op_sel_hi:[1,0,0]
    v_pk_fma_f32 v[122:123], v[122:123], v[198:199], v[196:197] op_sel_hi:[1,0,0]
    v_pk_fma_f32 v[124:125], v[124:125], v[198:199], v[196:197] op_sel_hi:[1,0,0]
    v_pk_fma_f32 v[126:127], v[126:127], v[198:199], v[196:197] op_sel_hi:[1,0,0]
    v_cvt_pk_bf16_f32 v120, v120, v121
    v_cvt_pk_bf16_f32 v121, v122, v123
    v_cvt_pk_bf16_f32 v122, v124, v125
    v_cvt_pk_bf16_f32 v123, v126, v127
    ds_write_b128 v203, v[120:123] offset:8320
    v_pk_fma_f32 v[128:129], v[128:129], v[194:195], v[192:193] op_sel_hi:[1,0,0]
    v_pk_fma_f32 v[130:131], v[130:131], v[194:195], v[192:193] op_sel_hi:[1,0,0]
    v_pk_fma_f32 v[132:133], v[132:133], v[194:195], v[192:193] op_sel_hi:[1,0,0]
    v_pk_fma_f32 v[134:135], v[134:135], v[194:195], v[192:193] op_sel_hi:[1,0,0]
    v_cvt_pk_bf16_f32 v128, v128, v129
    v_cvt_pk_bf16_f32 v129, v130, v131
    v_cvt_pk_bf16_f32 v130, v132, v133
    v_cvt_pk_bf16_f32 v131, v134, v135
    ds_write_b128 v204, v[128:131] offset:0
    v_pk_fma_f32 v[136:137], v[136:137], v[198:199], v[196:197] op_sel_hi:[1,0,0]
    v_pk_fma_f32 v[138:139], v[138:139], v[198:199], v[196:197] op_sel_hi:[1,0,0]
    v_pk_fma_f32 v[140:141], v[140:141], v[198:199], v[196:197] op_sel_hi:[1,0,0]
    v_pk_fma_f32 v[142:143], v[142:143], v[198:199], v[196:197] op_sel_hi:[1,0,0]
    v_cvt_pk_bf16_f32 v136, v136, v137
    v_cvt_pk_bf16_f32 v137, v138, v139
    v_cvt_pk_bf16_f32 v138, v140, v141
    v_cvt_pk_bf16_f32 v139, v142, v143
    ds_write_b128 v204, v[136:139] offset:8320
    v_pk_fma_f32 v[144:145], v[144:145], v[194:195], v[192:193] op_sel_hi:[1,0,0]
    v_pk_fma_f32 v[146:147], v[146:147], v[194:195], v[192:193] op_sel_hi:[1,0,0]
    v_pk_fma_f32 v[148:149], v[148:149], v[194:195], v[192:193] op_sel_hi:[1,0,0]
    v_pk_fma_f32 v[150:151], v[150:151], v[194:195], v[192:193] op_sel_hi:[1,0,0]
    v_cvt_pk_bf16_f32 v144, v144, v145
    v_cvt_pk_bf16_f32 v145, v146, v147
    v_cvt_pk_bf16_f32 v146, v148, v149
    v_cvt_pk_bf16_f32 v147, v150, v151
    ds_write_b128 v205, v[144:147] offset:0
    v_pk_fma_f32 v[152:153], v[152:153], v[198:199], v[196:197] op_sel_hi:[1,0,0]
    v_pk_fma_f32 v[154:155], v[154:155], v[198:199], v[196:197] op_sel_hi:[1,0,0]
    v_pk_fma_f32 v[156:157], v[156:157], v[198:199], v[196:197] op_sel_hi:[1,0,0]
    v_pk_fma_f32 v[158:159], v[158:159], v[198:199], v[196:197] op_sel_hi:[1,0,0]
    v_cvt_pk_bf16_f32 v152, v152, v153
    v_cvt_pk_bf16_f32 v153, v154, v155
    v_cvt_pk_bf16_f32 v154, v156, v157
    v_cvt_pk_bf16_f32 v155, v158, v159
    ds_write_b128 v205, v[152:155] offset:8320
    v_pk_fma_f32 v[160:161], v[160:161], v[194:195], v[192:193] op_sel_hi:[1,0,0]
    v_pk_fma_f32 v[162:163], v[162:163], v[194:195], v[192:193] op_sel_hi:[1,0,0]
    v_pk_fma_f32 v[164:165], v[164:165], v[194:195], v[192:193] op_sel_hi:[1,0,0]
    v_pk_fma_f32 v[166:167], v[166:167], v[194:195], v[192:193] op_sel_hi:[1,0,0]
    v_cvt_pk_bf16_f32 v160, v160, v161
    v_cvt_pk_bf16_f32 v161, v162, v163
    v_cvt_pk_bf16_f32 v162, v164, v165
    v_cvt_pk_bf16_f32 v163, v166, v167
    ds_write_b128 v206, v[160:163] offset:0
    s_add_u32 m0, s13, 32768
    s_xor_b32 s91, s96, 2
    s_mul_i32 s91, s91, 196608
    s_add_u32 s91, s91, s64
    buffer_load_dwordx4 v2, s[28:31], s91 offen offset:0 lds
    v_pk_fma_f32 v[168:169], v[168:169], v[198:199], v[196:197] op_sel_hi:[1,0,0]
    v_pk_fma_f32 v[170:171], v[170:171], v[198:199], v[196:197] op_sel_hi:[1,0,0]
    v_pk_fma_f32 v[172:173], v[172:173], v[198:199], v[196:197] op_sel_hi:[1,0,0]
    v_pk_fma_f32 v[174:175], v[174:175], v[198:199], v[196:197] op_sel_hi:[1,0,0]
    v_cvt_pk_bf16_f32 v168, v168, v169
    v_cvt_pk_bf16_f32 v169, v170, v171
    v_cvt_pk_bf16_f32 v170, v172, v173
    v_cvt_pk_bf16_f32 v171, v174, v175
    ds_write_b128 v206, v[168:171] offset:8320
    buffer_load_dwordx4 v3, s[28:31], s91 offen offset:1024 lds
    v_pk_fma_f32 v[176:177], v[176:177], v[194:195], v[192:193] op_sel_hi:[1,0,0]
    v_pk_fma_f32 v[178:179], v[178:179], v[194:195], v[192:193] op_sel_hi:[1,0,0]
    v_pk_fma_f32 v[180:181], v[180:181], v[194:195], v[192:193] op_sel_hi:[1,0,0]
    v_pk_fma_f32 v[182:183], v[182:183], v[194:195], v[192:193] op_sel_hi:[1,0,0]
    v_cvt_pk_bf16_f32 v176, v176, v177
    v_cvt_pk_bf16_f32 v177, v178, v179
    v_cvt_pk_bf16_f32 v178, v180, v181
    v_cvt_pk_bf16_f32 v179, v182, v183
    ds_write_b128 v207, v[176:179] offset:0
    buffer_load_dwordx4 v4, s[28:31], s91 offen offset:2048 lds
    v_pk_fma_f32 v[184:185], v[184:185], v[198:199], v[196:197] op_sel_hi:[1,0,0]
    v_pk_fma_f32 v[186:187], v[186:187], v[198:199], v[196:197] op_sel_hi:[1,0,0]
    v_pk_fma_f32 v[188:189], v[188:189], v[198:199], v[196:197] op_sel_hi:[1,0,0]
    v_pk_fma_f32 v[190:191], v[190:191], v[198:199], v[196:197] op_sel_hi:[1,0,0]
    v_cvt_pk_bf16_f32 v184, v184, v185
    v_cvt_pk_bf16_f32 v185, v186, v187
    v_cvt_pk_bf16_f32 v186, v188, v189
    v_cvt_pk_bf16_f32 v187, v190, v191
    ds_write_b128 v207, v[184:187] offset:8320
    buffer_load_dwordx4 v5, s[28:31], s91 offen offset:3072 lds
    s_xor_b32 s74, s96, 0
    s_lshl_b32 s74, s74, 7
    v_add_u32 v59, s74, v14
    s_waitcnt vmcnt(8)
    s_waitcnt lgkmcnt(0)
    s_barrier
    ds_read_b128 a[0:3], v59 offset:0
    ds_read_b64_tr_b16 v[64:65], v15 offset:0
    ds_read_b64_tr_b16 v[66:67], v15 offset:512
    ds_read_b64_tr_b16 v[68:69], v15 offset:8192
    ds_read_b64_tr_b16 v[70:71], v15 offset:8704
    ds_read_b128 a[4:7], v59 offset:32
    ds_read_b64_tr_b16 v[72:73], v15 offset:2048
    ds_read_b64_tr_b16 v[74:75], v15 offset:2560
    ds_read_b64_tr_b16 v[76:77], v15 offset:10240
    ds_read_b64_tr_b16 v[78:79], v15 offset:10752
    ds_read_b128 a[8:11], v59 offset:64
    ds_read_b64_tr_b16 v[80:81], v15 offset:4096
    ds_read_b64_tr_b16 v[82:83], v15 offset:4608
    ds_read_b64_tr_b16 v[84:85], v15 offset:12288
    ds_read_b64_tr_b16 v[86:87], v15 offset:12800
    ds_read_b128 a[12:15], v59 offset:96
    ds_read_b64_tr_b16 v[88:89], v15 offset:6144
    ds_read_b64_tr_b16 v[90:91], v15 offset:6656
    ds_read_b64_tr_b16 v[92:93], v15 offset:14336
    ds_read_b64_tr_b16 v[94:95], v15 offset:14848
    s_xor_b32 s74, s96, 1
    s_lshl_b32 s74, s74, 7
    v_add_u32 v59, s74, v14
    s_waitcnt lgkmcnt(15)
    v_mfma_f32_32x32x16_bf16 v[224:239], v[64:67], a[0:3], 0
    s_waitcnt vmcnt(4)
    s_barrier
    ds_read_b128 a[16:19], v59 offset:0
    ds_read_b64_tr_b16 v[96:97], v15 offset:16384
    s_add_u32 m0, s13, 49152
    s_xor_b32 s91, s96, 3
    s_mul_i32 s91, s91, 196608
    s_add_u32 s91, s91, s64
    buffer_load_dwordx4 v2, s[28:31], s91 offen offset:0 lds
    v_mfma_f32_32x32x16_bf16 v[240:255], a[0:3], v[68:71], 0
    s_waitcnt lgkmcnt(12)
    ds_read_b64_tr_b16 v[98:99], v15 offset:16896
    ds_read_b64_tr_b16 v[100:101], v15 offset:24576
    ds_read_b64_tr_b16 v[102:103], v15 offset:25088
    buffer_load_dwordx4 v3, s[28:31], s91 offen offset:1024 lds
    v_add_u32 v11, 7168, v10
    v_mfma_f32_32x32x16_bf16 v[224:239], v[72:75], a[4:7], v[224:239]
    ds_read_b128 a[20:23], v59 offset:32
    ds_read_b64_tr_b16 v[104:105], v15 offset:18432
    ds_read_b64_tr_b16 v[106:107], v15 offset:18944
    buffer_load_dwordx4 v4, s[28:31], s91 offen offset:2048 lds
    v_add_u32 v7, 27648, v6
    v_mfma_f32_32x32x16_bf16 v[240:255], a[4:7], v[76:79], v[240:255]
    s_waitcnt lgkmcnt(13)
    ds_read_b64_tr_b16 v[108:109], v15 offset:26624
    ds_read_b64_tr_b16 v[110:111], v15 offset:27136
    buffer_load_dwordx4 v5, s[28:31], s91 offen offset:3072 lds
    s_add_u32 m0, s13, 65536
    s_xor_b32 s91, s96, 4
    s_mul_i32 s91, s91, 196608
    s_add_u32 s91, s91, s64
    v_mfma_f32_32x32x16_bf16 v[224:239], v[80:83], a[8:11], v[224:239]
    ds_read_b128 a[24:27], v59 offset:64
    ds_read_b64_tr_b16 v[112:113], v15 offset:20480
    ds_read_b64_tr_b16 v[114:115], v15 offset:20992
    buffer_load_dwordx4 v2, s[28:31], s91 offen offset:0 lds
    v_add_u32 v12, 14336, v10
    v_mfma_f32_32x32x16_bf16 v[240:255], a[8:11], v[84:87], v[240:255]
    s_waitcnt lgkmcnt(13)
    ds_read_b64_tr_b16 v[116:117], v15 offset:28672
    ds_read_b64_tr_b16 v[118:119], v15 offset:29184
    buffer_load_dwordx4 v3, s[28:31], s91 offen offset:1024 lds
    v_add_u32 v8, 55296, v6
    v_add_u32 v13, 21504, v10
    v_mfma_f32_32x32x16_bf16 v[224:239], v[88:91], a[12:15], v[224:239]
    ds_read_b128 a[28:31], v59 offset:96
    ds_read_b64_tr_b16 v[120:121], v15 offset:22528
    ds_read_b64_tr_b16 v[122:123], v15 offset:23040
    buffer_load_dwordx4 v4, s[28:31], s91 offen offset:2048 lds
    v_add_u32 v9, 82944, v6
    v_mfma_f32_32x32x16_bf16 v[240:255], a[12:15], v[92:95], v[240:255]
    s_waitcnt lgkmcnt(13)
    ds_read_b64_tr_b16 v[124:125], v15 offset:30720
    ds_read_b64_tr_b16 v[126:127], v15 offset:31232
    s_xor_b32 s74, s96, 2
    s_lshl_b32 s74, s74, 7
    v_add_u32 v59, s74, v14
    buffer_load_dwordx4 v5, s[28:31], s91 offen offset:3072 lds
    v_mfma_f32_32x32x16_bf16 v[224:239], v[96:99], a[16:19], v[224:239]
    s_waitcnt vmcnt(8)
    s_barrier
    ds_read_b128 a[32:35], v59 offset:0
    ds_read_b64_tr_b16 v[64:65], v15 offset:32768
    s_add_u32 m0, s13, 0
    s_xor_b32 s91, s96, 5
    s_mul_i32 s91, s91, 196608
    v_mfma_f32_32x32x16_bf16 v[240:255], a[16:19], v[100:103], v[240:255]
    s_waitcnt lgkmcnt(12)
    ds_read_b64_tr_b16 v[66:67], v15 offset:33280
    ds_read_b64_tr_b16 v[68:69], v15 offset:40960
    ds_read_b64_tr_b16 v[70:71], v15 offset:41472
    s_add_u32 s91, s91, s64
    buffer_load_dwordx4 v2, s[28:31], s91 offen offset:0 lds
    v_mfma_f32_32x32x16_bf16 v[224:239], v[104:107], a[20:23], v[224:239]
    ds_read_b128 a[36:39], v59 offset:32
    ds_read_b64_tr_b16 v[72:73], v15 offset:34816
    ds_read_b64_tr_b16 v[74:75], v15 offset:35328
    v_lshl_add_u32 v53, v51, 2, v57
    v_lshlrev_b32 v53, 7, v53
    s_lshl_b32 s69, s12, 13
    v_mfma_f32_32x32x16_bf16 v[240:255], a[20:23], v[108:111], v[240:255]
    s_waitcnt lgkmcnt(13)
    ds_read_b64_tr_b16 v[76:77], v15 offset:43008
    ds_read_b64_tr_b16 v[78:79], v15 offset:43520
    buffer_load_dwordx4 v3, s[28:31], s91 offen offset:1024 lds
    v_add3_u32 v25, v53, v52, s69
    v_xor_b32 v26, 64, v25
    v_mfma_f32_32x32x16_bf16 v[224:239], v[112:115], a[24:27], v[224:239]
    ds_read_b128 a[40:43], v59 offset:64
    ds_read_b64_tr_b16 v[80:81], v15 offset:36864
    ds_read_b64_tr_b16 v[82:83], v15 offset:37376
    v_add_u32 v27, 65536, v25
    v_add_u32 v28, 65536, v26
    v_add_u32 v29, 131072, v25
    v_mfma_f32_32x32x16_bf16 v[240:255], a[24:27], v[116:119], v[240:255]
    s_waitcnt lgkmcnt(13)
    ds_read_b64_tr_b16 v[84:85], v15 offset:45056
    ds_read_b64_tr_b16 v[86:87], v15 offset:45568
    buffer_load_dwordx4 v4, s[28:31], s91 offen offset:2048 lds
    v_add_u32 v30, 131072, v26
    v_lshl_add_u32 v53, v50, 9, v53
    v_mfma_f32_32x32x16_bf16 v[224:239], v[120:123], a[28:31], v[224:239]
    ds_read_b128 a[44:47], v59 offset:96
    ds_read_b64_tr_b16 v[88:89], v15 offset:38912
    ds_read_b64_tr_b16 v[90:91], v15 offset:39424
    s_xor_b32 s69, s3, 0
    s_lshl_b32 s69, s69, 5
    v_xor_b32 v52, s69, v58
    v_mfma_f32_32x32x16_bf16 v[240:255], a[28:31], v[124:127], v[240:255]
    s_waitcnt lgkmcnt(13)
    ds_read_b64_tr_b16 v[92:93], v15 offset:47104
    ds_read_b64_tr_b16 v[94:95], v15 offset:47616
    s_xor_b32 s74, s96, 3
    s_lshl_b32 s74, s74, 7
    v_add_u32 v59, s74, v14
    buffer_load_dwordx4 v5, s[28:31], s91 offen offset:3072 lds
    v_mfma_f32_32x32x16_bf16 v[224:239], v[64:67], a[32:35], v[224:239]
    s_waitcnt vmcnt(8)
    s_barrier
    ds_read_b128 a[48:51], v59 offset:0
    ds_read_b64_tr_b16 v[96:97], v15 offset:49152
    s_add_u32 m0, s13, 16384
    s_xor_b32 s91, s96, 6
    s_mul_i32 s91, s91, 196608
    v_mfma_f32_32x32x16_bf16 v[240:255], a[32:35], v[68:71], v[240:255]
    s_waitcnt lgkmcnt(12)
    ds_read_b64_tr_b16 v[98:99], v15 offset:49664
    ds_read_b64_tr_b16 v[100:101], v15 offset:57344
    ds_read_b64_tr_b16 v[102:103], v15 offset:57856
    s_add_u32 s91, s91, s64
    buffer_load_dwordx4 v2, s[28:31], s91 offen offset:0 lds
    v_mfma_f32_32x32x16_bf16 v[224:239], v[72:75], a[36:39], v[224:239]
    ds_read_b128 a[52:55], v59 offset:32
    ds_read_b64_tr_b16 v[104:105], v15 offset:51200
    ds_read_b64_tr_b16 v[106:107], v15 offset:51712
    v_add_u32 v17, v53, v52
    v_add_u32 v21, 0x10000, v17
    s_xor_b32 s69, s3, 1
    v_mfma_f32_32x32x16_bf16 v[240:255], a[36:39], v[76:79], v[240:255]
    s_waitcnt lgkmcnt(13)
    ds_read_b64_tr_b16 v[108:109], v15 offset:59392
    ds_read_b64_tr_b16 v[110:111], v15 offset:59904
    buffer_load_dwordx4 v3, s[28:31], s91 offen offset:1024 lds
    s_lshl_b32 s69, s69, 5
    v_xor_b32 v52, s69, v58
    v_mfma_f32_32x32x16_bf16 v[224:239], v[80:83], a[40:43], v[224:239]
    ds_read_b128 a[56:59], v59 offset:64
    ds_read_b64_tr_b16 v[112:113], v15 offset:53248
    ds_read_b64_tr_b16 v[114:115], v15 offset:53760
    v_add_u32 v18, v53, v52
    v_add_u32 v22, 0x10000, v18
    s_xor_b32 s69, s3, 2
    v_mfma_f32_32x32x16_bf16 v[240:255], a[40:43], v[84:87], v[240:255]
    s_waitcnt lgkmcnt(13)
    ds_read_b64_tr_b16 v[116:117], v15 offset:61440
    ds_read_b64_tr_b16 v[118:119], v15 offset:61952
    buffer_load_dwordx4 v4, s[28:31], s91 offen offset:2048 lds
    s_lshl_b32 s69, s69, 5
    v_xor_b32 v52, s69, v58
    v_mfma_f32_32x32x16_bf16 v[224:239], v[88:91], a[44:47], v[224:239]
    ds_read_b128 a[60:63], v59 offset:96
    ds_read_b64_tr_b16 v[120:121], v15 offset:55296
    ds_read_b64_tr_b16 v[122:123], v15 offset:55808
    v_add_u32 v19, v53, v52
    v_add_u32 v23, 0x10000, v19
    s_xor_b32 s69, s3, 3
    v_mfma_f32_32x32x16_bf16 v[240:255], a[44:47], v[92:95], v[240:255]
    s_waitcnt lgkmcnt(13)
    ds_read_b64_tr_b16 v[124:125], v15 offset:63488
    ds_read_b64_tr_b16 v[126:127], v15 offset:64000
    s_xor_b32 s74, s96, 4
    s_lshl_b32 s74, s74, 7
    v_add_u32 v59, s74, v14
    buffer_load_dwordx4 v5, s[28:31], s91 offen offset:3072 lds
    v_mfma_f32_32x32x16_bf16 v[224:239], v[96:99], a[48:51], v[224:239]
    s_waitcnt vmcnt(8)
    s_barrier
    ds_read_b128 a[64:67], v59 offset:0
    ds_read_b64_tr_b16 v[64:65], v16 offset:0
    s_add_u32 m0, s13, 32768
    s_xor_b32 s91, s96, 7
    s_mul_i32 s91, s91, 196608
    v_mfma_f32_32x32x16_bf16 v[240:255], a[48:51], v[100:103], v[240:255]
    s_waitcnt lgkmcnt(12)
    ds_read_b64_tr_b16 v[66:67], v16 offset:512
    ds_read_b64_tr_b16 v[68:69], v16 offset:8192
    ds_read_b64_tr_b16 v[70:71], v16 offset:8704
    s_add_u32 s91, s91, s64
    buffer_load_dwordx4 v2, s[28:31], s91 offen offset:0 lds
    v_mfma_f32_32x32x16_bf16 v[224:239], v[104:107], a[52:55], v[224:239]
    ds_read_b128 a[68:71], v59 offset:32
    ds_read_b64_tr_b16 v[72:73], v16 offset:2048
    ds_read_b64_tr_b16 v[74:75], v16 offset:2560
    s_lshl_b32 s69, s69, 5
    v_xor_b32 v52, s69, v58
    v_add_u32 v20, v53, v52
    v_mfma_f32_32x32x16_bf16 v[240:255], a[52:55], v[108:111], v[240:255]
    s_waitcnt lgkmcnt(13)
    ds_read_b64_tr_b16 v[76:77], v16 offset:10240
    ds_read_b64_tr_b16 v[78:79], v16 offset:10752
    buffer_load_dwordx4 v3, s[28:31], s91 offen offset:1024 lds
    v_add_u32 v24, 0x10000, v20
    s_lshl1_add_u32 s63, s7, s12
    v_mfma_f32_32x32x16_bf16 v[224:239], v[112:115], a[56:59], v[224:239]
    ds_read_b128 a[72:75], v59 offset:64
    ds_read_b64_tr_b16 v[80:81], v16 offset:4096
    ds_read_b64_tr_b16 v[82:83], v16 offset:4608
    s_lshl_b32 s70, s63, 15
    s_lshl_b32 s71, s15, 11
    s_add_u32 s70, s70, s71
    v_mfma_f32_32x32x16_bf16 v[240:255], a[56:59], v[116:119], v[240:255]
    s_waitcnt lgkmcnt(13)
    ds_read_b64_tr_b16 v[84:85], v16 offset:12288
    ds_read_b64_tr_b16 v[86:87], v16 offset:12800
    buffer_load_dwordx4 v4, s[28:31], s91 offen offset:2048 lds
    s_add_u32 s70, s70, 2097152
    s_add_u32 s71, s70, 0x4000
    v_mfma_f32_32x32x16_bf16 v[224:239], v[120:123], a[60:63], v[224:239]
    ds_read_b128 a[76:79], v59 offset:96
    ds_read_b64_tr_b16 v[88:89], v16 offset:6144
    ds_read_b64_tr_b16 v[90:91], v16 offset:6656
    s_lshl_b32 s69, s63, 10
    s_add_u32 s69, s69, 1998848
    s_lshl_b32 s63, s15, 7
    v_mfma_f32_32x32x16_bf16 v[240:255], a[60:63], v[124:127], v[240:255]
    s_waitcnt lgkmcnt(13)
    ds_read_b64_tr_b16 v[92:93], v16 offset:14336
    ds_read_b64_tr_b16 v[94:95], v16 offset:14848
    s_xor_b32 s74, s96, 5
    s_lshl_b32 s74, s74, 7
    v_add_u32 v59, s74, v14
    buffer_load_dwordx4 v5, s[28:31], s91 offen offset:3072 lds
    v_mfma_f32_32x32x16_bf16 v[224:239], v[64:67], a[64:67], v[224:239]
    s_waitcnt vmcnt(8)
    s_barrier
    ds_read_b128 a[80:83], v59 offset:0
    ds_read_b64_tr_b16 v[96:97], v15 offset:0
    s_add_u32 m0, s13, 49152
    s_xor_b32 s91, s85, 0
    s_mul_i32 s91, s91, 393216
    v_mfma_f32_32x32x16_bf16 v[240:255], a[64:67], v[68:71], v[240:255]
    s_waitcnt lgkmcnt(12)
    ds_read_b64_tr_b16 v[98:99], v15 offset:512
    ds_read_b64_tr_b16 v[100:101], v15 offset:8192
    ds_read_b64_tr_b16 v[102:103], v15 offset:8704
    s_add_u32 s91, s91, s65
    buffer_load_dwordx4 v2, s[28:31], s91 offen offset:0 lds
    v_mfma_f32_32x32x16_bf16 v[224:239], v[72:75], a[68:71], v[224:239]
    ds_read_b128 a[84:87], v59 offset:32
    ds_read_b64_tr_b16 v[104:105], v15 offset:2048
    ds_read_b64_tr_b16 v[106:107], v15 offset:2560
    s_add_u32 s72, s69, s63
    s_add_u32 s72, s72, 2097152
    v_and_b32 v50, 15, v0
    v_mfma_f32_32x32x16_bf16 v[240:255], a[68:71], v[76:79], v[240:255]
    s_waitcnt lgkmcnt(13)
    ds_read_b64_tr_b16 v[108:109], v15 offset:10240
    ds_read_b64_tr_b16 v[110:111], v15 offset:10752
    buffer_load_dwordx4 v3, s[28:31], s91 offen offset:1024 lds
    v_lshrrev_b32 v51, 5, v0
    v_lshlrev_b32 v50, 4, v50
    v_mfma_f32_32x32x16_bf16 v[224:239], v[80:83], a[72:75], v[224:239]
    ds_read_b128 a[88:91], v59 offset:64
    ds_read_b64_tr_b16 v[112:113], v15 offset:4096
    ds_read_b64_tr_b16 v[114:115], v15 offset:4608
    v_lshl_add_u32 v60, v51, 8, v50
    v_and_b32 v50, 16, v0
    v_lshl_add_u32 v52, v50, 10, v60
    v_mfma_f32_32x32x16_bf16 v[240:255], a[72:75], v[84:87], v[240:255]
    s_waitcnt lgkmcnt(13)
    ds_read_b64_tr_b16 v[116:117], v15 offset:12288
    ds_read_b64_tr_b16 v[118:119], v15 offset:12800
    buffer_load_dwordx4 v4, s[28:31], s91 offen offset:2048 lds
    v_lshl_add_u32 v53, v50, 8, v60
    s_lshl_b32 s63, s12, 13
    v_mfma_f32_32x32x16_bf16 v[224:239], v[88:91], a[76:79], v[224:239]
    ds_read_b128 a[92:95], v59 offset:96
    ds_read_b64_tr_b16 v[120:121], v15 offset:6144
    ds_read_b64_tr_b16 v[122:123], v15 offset:6656
    s_lshl_b32 s73, s11, 11
    s_add_u32 s63, s63, s73
    s_add_u32 s63, s63, 32768
    v_mfma_f32_32x32x16_bf16 v[240:255], a[76:79], v[92:95], v[240:255]
    s_waitcnt lgkmcnt(13)
    ds_read_b64_tr_b16 v[124:125], v15 offset:14336
    ds_read_b64_tr_b16 v[126:127], v15 offset:14848
    s_xor_b32 s74, s96, 6
    s_lshl_b32 s74, s74, 7
    v_add_u32 v59, s74, v14
    buffer_load_dwordx4 v5, s[28:31], s91 offen offset:3072 lds
    v_mfma_f32_32x32x16_bf16 v[224:239], v[96:99], a[80:83], v[224:239]
    s_waitcnt vmcnt(8)
    s_barrier
    ds_read_b128 a[96:99], v59 offset:0
    ds_read_b64_tr_b16 v[64:65], v15 offset:16384
    s_add_u32 m0, s13, 65536
    s_xor_b32 s91, s85, 1
    s_mul_i32 s91, s91, 393216
    v_mfma_f32_32x32x16_bf16 v[240:255], a[80:83], v[100:103], v[240:255]
    s_waitcnt lgkmcnt(12)
    ds_read_b64_tr_b16 v[66:67], v15 offset:16896
    ds_read_b64_tr_b16 v[68:69], v15 offset:24576
    ds_read_b64_tr_b16 v[70:71], v15 offset:25088
    s_add_u32 s91, s91, s65
    buffer_load_dwordx4 v2, s[28:31], s91 offen offset:0 lds
    v_mfma_f32_32x32x16_bf16 v[224:239], v[104:107], a[84:87], v[224:239]
    ds_read_b128 a[100:103], v59 offset:32
    ds_read_b64_tr_b16 v[72:73], v15 offset:18432
    ds_read_b64_tr_b16 v[74:75], v15 offset:18944
    v_add_u32 v53, s63, v53
    v_add_u32 v54, s63, v1
    v_mov_b32 v144, s14
    v_mfma_f32_32x32x16_bf16 v[240:255], a[84:87], v[108:111], v[240:255]
    s_waitcnt lgkmcnt(13)
    ds_read_b64_tr_b16 v[76:77], v15 offset:26624
    ds_read_b64_tr_b16 v[78:79], v15 offset:27136
    buffer_load_dwordx4 v3, s[28:31], s91 offen offset:1024 lds
    v_and_b32 v145, 31, v0
    v_lshlrev_b32 v145, 2, v145
    v_mfma_f32_32x32x16_bf16 v[224:239], v[112:115], a[88:91], v[224:239]
    ds_read_b128 a[104:107], v59 offset:64
    ds_read_b64_tr_b16 v[80:81], v15 offset:20480
    ds_read_b64_tr_b16 v[82:83], v15 offset:20992
    s_lshl_b32 s21, s3, 15
    s_add_u32 s21, s21, s94
    v_bfe_u32 v147, v0, 2, 1
    v_mfma_f32_32x32x16_bf16 v[240:255], a[88:91], v[116:119], v[240:255]
    s_waitcnt lgkmcnt(13)
    ds_read_b64_tr_b16 v[84:85], v15 offset:28672
    ds_read_b64_tr_b16 v[86:87], v15 offset:29184
    buffer_load_dwordx4 v4, s[28:31], s91 offen offset:2048 lds
    v_and_b32 v150, 7, v0
    v_subrev_u32 v147, 1, v147
    v_mfma_f32_32x32x16_bf16 v[224:239], v[120:123], a[92:95], v[224:239]
    ds_read_b128 a[108:111], v59 offset:96
    ds_read_b64_tr_b16 v[88:89], v15 offset:22528
    ds_read_b64_tr_b16 v[90:91], v15 offset:23040
    v_lshlrev_b32 v150, 2, v150
    v_and_b32 v147, 1065369472, v147
    v_add_u32 v150, 149504, v150
    v_mfma_f32_32x32x16_bf16 v[240:255], a[92:95], v[124:127], v[240:255]
    s_waitcnt lgkmcnt(13)
    ds_read_b64_tr_b16 v[92:93], v15 offset:30720
    ds_read_b64_tr_b16 v[94:95], v15 offset:31232
    s_xor_b32 s74, s96, 7
    s_lshl_b32 s74, s74, 7
    v_add_u32 v59, s74, v14
    buffer_load_dwordx4 v5, s[28:31], s91 offen offset:3072 lds
    v_mfma_f32_32x32x16_bf16 v[224:239], v[64:67], a[96:99], v[224:239]
    s_waitcnt vmcnt(8)
    s_barrier
    ds_read_b128 a[112:115], v59 offset:0
    ds_read_b64_tr_b16 v[96:97], v15 offset:32768
    s_add_u32 m0, s13, 0
    s_xor_b32 s91, s85, 2
    s_mul_i32 s91, s91, 393216
    v_mfma_f32_32x32x16_bf16 v[240:255], a[96:99], v[68:71], v[240:255]
    s_waitcnt lgkmcnt(12)
    ds_read_b64_tr_b16 v[98:99], v15 offset:33280
    ds_read_b64_tr_b16 v[100:101], v15 offset:40960
    ds_read_b64_tr_b16 v[102:103], v15 offset:41472
    s_add_u32 s91, s91, s65
    buffer_load_dwordx4 v2, s[28:31], s91 offen offset:0 lds
    v_mfma_f32_32x32x16_bf16 v[224:239], v[72:75], a[100:103], v[224:239]
    ds_read_b128 a[116:119], v59 offset:32
    ds_read_b64_tr_b16 v[104:105], v15 offset:34816
    ds_read_b64_tr_b16 v[106:107], v15 offset:35328
    ds_write_b32 v150, v147
    v_mov_b32 v147, 149504
    s_waitcnt lgkmcnt(0)
    v_mfma_f32_32x32x16_bf16 v[240:255], a[100:103], v[76:79], v[240:255]
    ds_read_b64_tr_b16 v[108:109], v15 offset:43008
    ds_read_b64_tr_b16 v[110:111], v15 offset:43520
    buffer_load_dwordx4 v3, s[28:31], s91 offen offset:1024 lds
    ds_read_b128 a[228:231], v147
    ds_read_b128 a[232:235], v147
    v_mfma_f32_32x32x16_bf16 v[224:239], v[80:83], a[104:107], v[224:239]
    ds_read_b128 a[120:123], v59 offset:64
    ds_read_b64_tr_b16 v[112:113], v15 offset:36864
    ds_read_b64_tr_b16 v[114:115], v15 offset:37376
    ds_read_b128 a[240:243], v147
    ds_read_b128 a[244:247], v147
    s_cmp_ge_u32 s8, 4
    s_cselect_b32 s75, 0, 16
    v_mfma_f32_32x32x16_bf16 v[240:255], a[104:107], v[84:87], v[240:255]
    ds_read_b64_tr_b16 v[116:117], v15 offset:45056
    ds_read_b64_tr_b16 v[118:119], v15 offset:45568
    buffer_load_dwordx4 v4, s[28:31], s91 offen offset:2048 lds
    s_add_u32 s75, s75, 149504
    v_mov_b32 v147, s75
    v_mfma_f32_32x32x16_bf16 v[224:239], v[88:91], a[108:111], v[224:239]
    ds_read_b128 a[124:127], v59 offset:96
    ds_read_b64_tr_b16 v[120:121], v15 offset:38912
    ds_read_b64_tr_b16 v[122:123], v15 offset:39424
    ds_read_b128 a[132:135], v147
    ds_read_b128 a[136:139], v147
    ds_read_b128 a[144:147], v147
    v_mfma_f32_32x32x16_bf16 v[240:255], a[108:111], v[92:95], v[240:255]
    ds_read_b64_tr_b16 v[124:125], v15 offset:47104
    ds_read_b64_tr_b16 v[126:127], v15 offset:47616
    buffer_load_dwordx4 v5, s[28:31], s91 offen offset:3072 lds
    ds_read_b128 a[148:151], v147
    s_cmp_ge_u32 s8, 3
    s_cselect_b32 s75, 0, 16
    v_mfma_f32_32x32x16_bf16 v[224:239], v[96:99], a[112:115], v[224:239]
    s_waitcnt lgkmcnt(15)
    s_barrier
    s_add_u32 m0, s13, 16384
    s_xor_b32 s91, s85, 3
    s_mul_i32 s91, s91, 393216
    s_add_u32 s91, s91, s65
    s_add_u32 s75, s75, 149504
    v_mfma_f32_32x32x16_bf16 v[224:239], v[104:107], a[116:119], v[224:239]
    s_waitcnt lgkmcnt(9)
    buffer_load_dwordx4 v2, s[28:31], s91 offen offset:0 lds
    v_mov_b32 v147, s75
    ds_read_b128 a[156:159], v147
    ds_read_b128 a[160:163], v147
    ds_read_b128 a[168:171], v147
    v_mfma_f32_32x32x16_bf16 v[224:239], v[112:115], a[120:123], v[224:239]
    s_waitcnt lgkmcnt(4)
    ds_read_b128 a[172:175], v147
    s_cmp_ge_u32 s8, 2
    s_cselect_b32 s75, 0, 16
    s_add_u32 s75, s75, 149504
    v_mov_b32 v147, s75
    ds_read_b128 a[180:183], v147
    v_mfma_f32_32x32x16_bf16 v[224:239], v[120:123], a[124:127], v[224:239]
    buffer_load_dwordx4 v3, s[28:31], s91 offen offset:1024 lds
    ds_read_b128 a[184:187], v147
    ds_read_b128 a[192:195], v147
    ds_read_b128 a[196:199], v147
    s_cmp_ge_u32 s8, 1
    s_cselect_b32 s75, 0, 16
    v_mfma_f32_32x32x16_bf16 v[240:255], a[112:115], v[100:103], v[240:255]
    s_add_u32 s75, s75, 149504
    v_mov_b32 v147, s75
    ds_read_b128 a[204:207], v147
    ds_read_b128 a[208:211], v147
    ds_read_b128 a[216:219], v147
    ds_read_b128 a[220:223], v147
    v_mfma_f32_32x32x16_bf16 v[240:255], a[116:119], v[108:111], v[240:255]
    buffer_load_dwordx4 v4, s[28:31], s91 offen offset:2048 lds
    v_mfma_f32_32x32x16_bf16 v[240:255], a[120:123], v[116:119], v[240:255]
    v_mfma_f32_32x32x16_bf16 v[240:255], a[124:127], v[124:127], v[240:255]
    buffer_load_dwordx4 v5, s[28:31], s91 offen offset:3072 lds
    v_cvt_pk_bf16_f32 v128, v224, v225
    v_cvt_pk_bf16_f32 v129, v226, v227
    v_cvt_pk_bf16_f32 v130, v228, v229
    v_cvt_pk_bf16_f32 v131, v230, v231
    v_cvt_pk_bf16_f32 v132, v232, v233
    v_cvt_pk_bf16_f32 v133, v234, v235
    v_cvt_pk_bf16_f32 v134, v236, v237
    v_cvt_pk_bf16_f32 v135, v238, v239
    buffer_store_dwordx4 v[128:131], v1, s[48:51], s70 offen sc1
    buffer_store_dwordx4 v[132:135], v1, s[48:51], s71 offen sc1
    s_nop 0
    v_cvt_pk_bf16_f32 v136, v240, v241
    v_cvt_pk_bf16_f32 v137, v242, v243
    v_cvt_pk_bf16_f32 v138, v244, v245
    v_cvt_pk_bf16_f32 v139, v246, v247
    v_cvt_pk_bf16_f32 v140, v248, v249
    v_cvt_pk_bf16_f32 v141, v250, v251
    v_cvt_pk_bf16_f32 v142, v252, v253
    v_cvt_pk_bf16_f32 v143, v254, v255
    buffer_store_dwordx4 v[136:139], v52, s[48:51], s70 offen offset:1024 sc1
    buffer_store_dwordx4 v[140:143], v52, s[48:51], s70 offen offset:1536 sc1
    s_waitcnt vmcnt(4)
    s_barrier
    ds_read_b64_tr_b16 v[64:65], v15 offset:49152
    ds_read_b64_tr_b16 v[66:67], v15 offset:49664
    ds_read_b64_tr_b16 v[68:69], v15 offset:51200
    ds_read_b64_tr_b16 v[70:71], v15 offset:51712
    ds_read_b64_tr_b16 v[72:73], v15 offset:53248
    ds_read_b64_tr_b16 v[74:75], v15 offset:53760
    ds_read_b64_tr_b16 v[76:77], v15 offset:55296
    ds_read_b64_tr_b16 v[78:79], v15 offset:55808
    ds_read_b64_tr_b16 v[80:81], v15 offset:57344
    ds_read_b64_tr_b16 v[82:83], v15 offset:57856
    ds_read_b64_tr_b16 v[84:85], v15 offset:59392
    ds_read_b64_tr_b16 v[86:87], v15 offset:59904
    s_waitcnt lgkmcnt(10)
    v_mfma_f32_32x32x16_bf16 v[208:223], v[64:67], a[0:3], 0
    s_waitcnt lgkmcnt(8)
    ds_read_b64_tr_b16 v[88:89], v15 offset:61440
    ds_read_b64_tr_b16 v[90:91], v15 offset:61952
    s_add_u32 m0, s13, 81920
    s_add_u32 s91, s21, 0
    ds_write_b128 v54, v[128:131]
    v_mfma_f32_32x32x16_bf16 v[208:223], v[68:71], a[4:7], v[208:223]
    s_waitcnt lgkmcnt(9)
    ds_read_b64_tr_b16 v[92:93], v15 offset:63488
    ds_read_b64_tr_b16 v[94:95], v15 offset:64000
    buffer_load_dwordx4 v10, s[32:35], s91 offen offset:0 lds
    ds_write_b128 v54, v[132:135] offset:4096
    v_mfma_f32_32x32x16_bf16 v[208:223], v[72:75], a[8:11], v[208:223]
    s_waitcnt lgkmcnt(10)
    ds_read_b64_tr_b16 v[96:97], v16 offset:0
    ds_read_b64_tr_b16 v[98:99], v16 offset:512
    ds_write_b128 v53, v[136:139] offset:1024
    v_mfma_f32_32x32x16_bf16 v[208:223], v[76:79], a[12:15], v[208:223]
    s_waitcnt lgkmcnt(11)
    ds_read_b64_tr_b16 v[100:101], v16 offset:2048
    ds_read_b64_tr_b16 v[102:103], v16 offset:2560
    buffer_load_dwordx4 v11, s[32:35], s91 offen offset:1024 lds
    ds_write_b128 v53, v[140:143] offset:1536
    v_mfma_f32_32x32x16_bf16 v[208:223], v[80:83], a[16:19], v[208:223]
    s_waitcnt lgkmcnt(12)
    ds_read_b64_tr_b16 v[104:105], v16 offset:4096
    ds_read_b64_tr_b16 v[106:107], v16 offset:4608
    v_and_b32 v50, 31, v0
    v_lshrrev_b32 v51, 5, v0
    v_lshlrev_b32 v146, 2, v51
    v_sub_u32 v146, v50, v146
    v_mfma_f32_32x32x16_bf16 v[208:223], v[84:87], a[20:23], v[208:223]
    s_waitcnt lgkmcnt(12)
    ds_read_b64_tr_b16 v[108:109], v16 offset:6144
    ds_read_b64_tr_b16 v[110:111], v16 offset:6656
    buffer_load_dwordx4 v12, s[32:35], s91 offen offset:2048 lds
    v_lshlrev_b32 v52, 10, v50
    v_lshl_add_u32 v62, v51, 3, v52
    v_mfma_f32_32x32x16_bf16 v[208:223], v[88:91], a[24:27], v[208:223]
    s_waitcnt lgkmcnt(11)
    ds_read_b64_tr_b16 v[112:113], v16 offset:8192
    ds_read_b64_tr_b16 v[114:115], v16 offset:8704
    s_lshl1_add_u32 s20, s8, s11
    s_lshl_b32 s20, s20, 15
    s_add_u32 s20, s20, s94
    s_lshl_b32 s63, s12, 6
    v_mfma_f32_32x32x16_bf16 v[208:223], v[92:95], a[28:31], v[208:223]
    s_waitcnt lgkmcnt(10)
    ds_read_b64_tr_b16 v[116:117], v16 offset:10240
    ds_read_b64_tr_b16 v[118:119], v16 offset:10752
    buffer_load_dwordx4 v13, s[32:35], s91 offen offset:3072 lds
    s_add_u32 m0, s13, 98304
    s_add_u32 s91, s21, 131072
    v_mfma_f32_32x32x16_bf16 v[208:223], v[96:99], a[32:35], v[208:223]
    s_waitcnt lgkmcnt(9)
    ds_read_b64_tr_b16 v[120:121], v16 offset:12288
    ds_read_b64_tr_b16 v[122:123], v16 offset:12800
    s_add_u32 s20, s20, s63
    v_lshrrev_b32 v51, 2, v50
    v_and_b32 v50, 3, v50
    v_lshlrev_b32 v50, 8, v50
    v_mfma_f32_32x32x16_bf16 v[208:223], v[100:103], a[36:39], v[208:223]
    s_waitcnt lgkmcnt(8)
    ds_read_b64_tr_b16 v[124:125], v16 offset:14336
    ds_read_b64_tr_b16 v[126:127], v16 offset:14848
    buffer_load_dwordx4 v10, s[32:35], s91 offen offset:0 lds
    v_lshl_add_u32 v50, v51, 11, v50
    v_add_u32 v63, 4096000, v50
    v_mfma_f32_32x32x16_bf16 v[208:223], v[104:107], a[40:43], v[208:223]
    s_waitcnt lgkmcnt(8)
    ds_read_b64_tr_b16 v[64:65], v15 offset:0
    ds_read_b64_tr_b16 v[66:67], v15 offset:512
    s_lshl_b32 s73, s6, 1
    v_min_u32 v50, 7, v0
    v_add_u32 v50, s73, v50
    s_sub_u32 s73, s4, 1
    v_mfma_f32_32x32x16_bf16 v[208:223], v[108:111], a[44:47], v[208:223]
    s_waitcnt lgkmcnt(8)
    ds_read_b64_tr_b16 v[68:69], v15 offset:2048
    ds_read_b64_tr_b16 v[70:71], v15 offset:2560
    buffer_load_dwordx4 v11, s[32:35], s91 offen offset:1024 lds
    s_lshr_b32 s73, s73, 28
    s_and_b32 s73, s73, 8
    v_mfma_f32_32x32x16_bf16 v[208:223], v[112:115], a[48:51], v[208:223]
    s_waitcnt lgkmcnt(8)
    ds_read_b64_tr_b16 v[72:73], v15 offset:4096
    ds_read_b64_tr_b16 v[74:75], v15 offset:4608
    v_max_u32 v50, s73, v50
    v_lshrrev_b32 v51, 3, v50
    v_and_b32 v50, 7, v50
    v_lshl_add_u32 v50, v50, 7, s69
    v_mfma_f32_32x32x16_bf16 v[208:223], v[116:119], a[52:55], v[208:223]
    s_waitcnt lgkmcnt(8)
    ds_read_b64_tr_b16 v[76:77], v15 offset:6144
    ds_read_b64_tr_b16 v[78:79], v15 offset:6656
    buffer_load_dwordx4 v12, s[32:35], s91 offen offset:2048 lds
    v_lshl_add_u32 v61, v51, 21, v50
    s_lshl2_add_u32 s63, s7, s3
    v_mfma_f32_32x32x16_bf16 v[208:223], v[120:123], a[56:59], v[208:223]
    s_waitcnt vmcnt(7) lgkmcnt(8)
    buffer_store_dword v144, v145, s[48:51], s72 offen sc1
    ds_read_b64_tr_b16 v[80:81], v15 offset:8192
    ds_read_b64_tr_b16 v[82:83], v15 offset:8704
    v_mfma_f32_32x32x16_bf16 v[208:223], v[124:127], a[60:63], v[208:223]
    s_waitcnt lgkmcnt(8)
    ds_read_b64_tr_b16 v[84:85], v15 offset:10240
    ds_read_b64_tr_b16 v[86:87], v15 offset:10752
    buffer_load_dwordx4 v13, s[32:35], s91 offen offset:3072 lds
    s_add_u32 m0, s13, 114688
    s_add_u32 s91, s21, 262144
    v_mfma_f32_32x32x16_bf16 v[208:223], v[64:67], a[64:67], v[208:223]
    s_waitcnt lgkmcnt(8)
    ds_read_b64_tr_b16 v[88:89], v15 offset:12288
    ds_read_b64_tr_b16 v[90:91], v15 offset:12800
    s_lshl_b32 s70, s63, 14
    s_lshl_b32 s71, s6, 12
    s_add_u32 s70, s70, s71
    s_mul_i32 s22, s11, 114688
    v_mfma_f32_32x32x16_bf16 v[208:223], v[68:71], a[68:71], v[208:223]
    s_waitcnt lgkmcnt(8)
    ds_read_b64_tr_b16 v[92:93], v15 offset:14336
    ds_read_b64_tr_b16 v[94:95], v15 offset:14848
    buffer_load_dwordx4 v10, s[32:35], s91 offen offset:0 lds
    s_lshl_b32 s63, s5, 7
    s_add_u32 s22, s22, s63
    v_mfma_f32_32x32x16_bf16 v[208:223], v[72:75], a[72:75], v[208:223]
    s_waitcnt lgkmcnt(8)
    ds_read_b64_tr_b16 v[96:97], v15 offset:16384
    ds_read_b64_tr_b16 v[98:99], v15 offset:16896
    s_lshl2_add_u32 s63, s7, s3
    s_lshl_b32 s86, s63, 10
    s_lshl_b32 s87, s6, 16
    s_add_u32 s86, s86, s87
    v_mfma_f32_32x32x16_bf16 v[208:223], v[76:79], a[76:79], v[208:223]
    s_waitcnt lgkmcnt(8)
    ds_read_b64_tr_b16 v[100:101], v15 offset:18432
    ds_read_b64_tr_b16 v[102:103], v15 offset:18944
    buffer_load_dwordx4 v11, s[32:35], s91 offen offset:1024 lds
    s_add_u32 s86, s86, 2621440
    s_add_u32 s87, s86, 32768
    v_mfma_f32_32x32x16_bf16 v[208:223], v[80:83], a[80:83], v[208:223]
    s_waitcnt lgkmcnt(8)
    ds_read_b64_tr_b16 v[104:105], v15 offset:20480
    ds_read_b64_tr_b16 v[106:107], v15 offset:20992
    s_lshl_b32 s89, s6, 5
    s_add_u32 s89, s89, s63
    s_lshl_b32 s89, s89, 2
    s_add_u32 s89, s89, 4112384
    v_mfma_f32_32x32x16_bf16 v[208:223], v[84:87], a[84:87], v[208:223]
    s_waitcnt lgkmcnt(8)
    ds_read_b64_tr_b16 v[108:109], v15 offset:22528
    ds_read_b64_tr_b16 v[110:111], v15 offset:23040
    buffer_load_dwordx4 v12, s[32:35], s91 offen offset:2048 lds
    s_lshl_b32 s84, s15, 15
    s_lshl_b32 s63, s94, 5
    v_mfma_f32_32x32x16_bf16 v[208:223], v[88:91], a[88:91], v[208:223]
    s_waitcnt lgkmcnt(8)
    ds_read_b64_tr_b16 v[112:113], v15 offset:24576
    ds_read_b64_tr_b16 v[114:115], v15 offset:25088
    s_add_u32 s84, s84, s63
    s_lshl_b32 s63, s12, 11
    s_add_u32 s84, s84, s63
    s_add_u32 s64, s84, 2883584
    v_mfma_f32_32x32x16_bf16 v[208:223], v[92:95], a[92:95], v[208:223]
    s_waitcnt lgkmcnt(8)
    ds_read_b64_tr_b16 v[116:117], v15 offset:26624
    ds_read_b64_tr_b16 v[118:119], v15 offset:27136
    buffer_load_dwordx4 v13, s[32:35], s91 offen offset:3072 lds
    s_add_u32 m0, s13, 131072
    s_add_u32 s91, s21, 393216
    v_mfma_f32_32x32x16_bf16 v[208:223], v[96:99], a[96:99], v[208:223]
    s_waitcnt lgkmcnt(8)
    ds_read_b64_tr_b16 v[120:121], v15 offset:28672
    ds_read_b64_tr_b16 v[122:123], v15 offset:29184
    s_lshr_b32 s99, s5, 1
    s_and_b32 s99, s99, 7
    s_xor_b32 s99, s99, s4
    s_mov_b32 s100, 0
    v_mfma_f32_32x32x16_bf16 v[208:223], v[100:103], a[100:103], v[208:223]
    s_waitcnt lgkmcnt(8)
    ds_read_b64_tr_b16 v[124:125], v15 offset:30720
    ds_read_b64_tr_b16 v[126:127], v15 offset:31232
    buffer_load_dwordx4 v10, s[32:35], s91 offen offset:0 lds
    s_and_b32 s16, s5, 1
    s_lshl2_add_u32 s17, s16, s3
    v_mfma_f32_32x32x16_bf16 v[208:223], v[104:107], a[104:107], v[208:223]
    s_waitcnt lgkmcnt(8)
    s_xor_b32 s18, s17, 4
    s_lshr_b32 s19, s6, 1
    v_and_b32 v50, 1, v0
    v_bfe_u32 v51, v0, 1, 1
    v_lshlrev_b32 v50, 7, v50
    v_lshl_add_u32 v50, v51, 11, v50
    v_mfma_f32_32x32x16_bf16 v[208:223], v[108:111], a[108:111], v[208:223]
    s_waitcnt lgkmcnt(6)
    buffer_load_dwordx4 v11, s[32:35], s91 offen offset:1024 lds
    s_lshl_b32 s63, s15, 12
    s_lshl1_add_u32 s63, s94, s63
    s_add_u32 s63, s63, 4063232
    v_add_u32 v56, s63, v50
    v_mfma_f32_32x32x16_bf16 v[208:223], v[112:115], a[112:115], v[208:223]
    s_waitcnt lgkmcnt(4)
    s_lshl_b32 s63, s6, 7
    s_add_u32 s63, s63, 4112384
    v_writelane_b32 v56, s63, 50
    s_lshl_b32 s63, s15, 7
    s_add_u32 s63, s63, 4113408
    v_writelane_b32 v56, s63, 51
    v_mfma_f32_32x32x16_bf16 v[208:223], v[116:119], a[116:119], v[208:223]
    s_waitcnt lgkmcnt(2)
    buffer_load_dwordx4 v12, s[32:35], s91 offen offset:2048 lds
    s_lshl_b32 s63, s15, 7
    s_add_u32 s63, s63, 4114432
    v_writelane_b32 v56, s63, 52
    s_mul_i32 s63, s12, 24576
    v_mfma_f32_32x32x16_bf16 v[208:223], v[120:123], a[120:123], v[208:223]
    s_waitcnt lgkmcnt(0)
    s_add_u32 s63, s63, 81920
    v_add_u32 v52, s63, v25
    v_add_u32 v53, s63, v26
    v_mov_b32 v57, 0x207
    v_sub_u32 v151, 31, v0
    v_ashrrev_i32 v151, 31, v151
    v_mfma_f32_32x32x16_bf16 v[208:223], v[124:127], a[124:127], v[208:223]
    buffer_load_dwordx4 v13, s[32:35], s91 offen offset:3072 lds
    v_and_b32 v151, 4286578688, v151
    v_xor_b32 v152, 4286578688, v151
    s_mov_b32 s63, 150016
    v_lshl_add_u32 v153, v0, 2, s63
    buffer_load_dword v58, v61, s[48:51], 0 offen sc1
    ds_write2_b32 v153, v151, v152 offset0:0 offset1:64
    v_sub_u32 v146, 31, v146
    v_lshl_add_u32 v146, v146, 2, s63
    s_waitcnt lgkmcnt(0)
    ds_read2_b32 v[176:177], v146 offset0:0 offset1:1
    ds_read2_b32 v[178:179], v146 offset0:2 offset1:3
    ds_read2_b32 v[180:181], v146 offset0:8 offset1:9
    ds_read2_b32 v[182:183], v146 offset0:10 offset1:11
    ds_read2_b32 v[184:185], v146 offset0:16 offset1:17
    ds_read2_b32 v[186:187], v146 offset0:18 offset1:19
    ds_read2_b32 v[188:189], v146 offset0:24 offset1:25
    ds_read2_b32 v[190:191], v146 offset0:26 offset1:27
    ds_read2_b32 v[192:193], v146 offset0:64 offset1:65
    ds_read2_b32 v[194:195], v146 offset0:66 offset1:67
    ds_read2_b32 v[196:197], v146 offset0:72 offset1:73
    ds_read2_b32 v[198:199], v146 offset0:74 offset1:75
    ds_read2_b32 v[200:201], v146 offset0:80 offset1:81
    ds_read2_b32 v[202:203], v146 offset0:82 offset1:83
    ds_read2_b32 v[204:205], v146 offset0:88 offset1:89
    ds_read2_b32 v[206:207], v146 offset0:90 offset1:91
    s_cmp_lg_u32 s4, 0
    s_cbranch_scc1 L_kz1
    v_mov_b32 v147, 149520
    ds_read_b128 a[128:131], v147
    ds_read_b128 a[140:143], v147
    ds_read_b128 a[152:155], v147
    ds_read_b128 a[164:167], v147
    ds_read_b128 a[176:179], v147
    ds_read_b128 a[188:191], v147
    ds_read_b128 a[200:203], v147
    ds_read_b128 a[212:215], v147
    s_waitcnt lgkmcnt(0)
L_kz1:
    s_mov_b32 s63, 0x3eb8aa3b
    s_lshl_b32 s73, s12, 12
    s_lshl_b32 s74, s11, 10
    s_add_u32 s73, s73, s74
    s_add_u32 s73, s73, 155648
    v_add_u32 v50, s73, v1
    s_add_u32 s73, s13, 32768
    v_add_u32 v59, s73, v1
    v_add_u32 v54, s73, v60
    s_lshl_b32 s73, s3, 11
    s_add_u32 s73, s73, 155648
    v_add_u32 v55, s73, v1
    v_mul_f32 v208, s63, v208
    v_mul_f32 v209, s63, v209
    v_mul_f32 v210, s63, v210
    v_mul_f32 v211, s63, v211
    v_mul_f32 v212, s63, v212
    v_mul_f32 v213, s63, v213
    v_mul_f32 v214, s63, v214
    v_mul_f32 v215, s63, v215
    v_cvt_pk_bf16_f32 v128, v208, v209
    v_cvt_pk_bf16_f32 v129, v210, v211
    v_cvt_pk_bf16_f32 v130, v212, v213
    v_cvt_pk_bf16_f32 v131, v214, v215
    ds_write_b128 v50, v[128:131] offset:0
    v_mul_f32 v216, s63, v216
    v_mul_f32 v217, s63, v217
    v_mul_f32 v218, s63, v218
    v_mul_f32 v219, s63, v219
    v_mul_f32 v220, s63, v220
    v_mul_f32 v221, s63, v221
    v_mul_f32 v222, s63, v222
    v_mul_f32 v223, s63, v223
    v_cvt_pk_bf16_f32 v132, v216, v217
    v_cvt_pk_bf16_f32 v133, v218, v219
    v_cvt_pk_bf16_f32 v134, v220, v221
    v_cvt_pk_bf16_f32 v135, v222, v223
    ds_write_b128 v50, v[132:135] offset:2048
    s_waitcnt lgkmcnt(0)
    s_barrier
    ds_read_b128 a[248:251], v55
    ds_read_b128 a[252:255], v55 offset:1024
    ds_read_b128 a[224:227], v59 offset:0
    ds_read_b128 a[236:239], v59 offset:2048
    s_mov_b32 exec_lo, 0xffff
    s_mov_b32 exec_hi, 0xffff
    ds_read_b128 a[228:231], v54 offset:1024
    ds_read_b128 a[232:235], v54 offset:1536
    ds_read_b128 a[240:243], v54 offset:3072
    ds_read_b128 a[244:247], v54 offset:3584
    s_mov_b64 exec, -1
    s_waitcnt lgkmcnt(0)
    v_mfma_f32_32x32x16_bf16 v[96:111], a[224:227], a[248:251], v[176:191]
    v_mfma_f32_32x32x16_bf16 v[112:127], a[224:227], a[252:255], 0
    s_nop 10
    v_exp_f32 v96, v96
    v_exp_f32 v97, v97
    v_exp_f32 v98, v98
    v_exp_f32 v99, v99
    v_cvt_pk_bf16_f32 v128, v96, v97
    v_exp_f32 v100, v100
    v_exp_f32 v101, v101
    v_cvt_pk_bf16_f32 v129, v98, v99
    v_exp_f32 v102, v102
    v_exp_f32 v103, v103
    v_cvt_pk_bf16_f32 v130, v100, v101
    v_exp_f32 v104, v104
    v_exp_f32 v105, v105
    v_cvt_pk_bf16_f32 v131, v102, v103
    v_exp_f32 v106, v106
    v_exp_f32 v107, v107
    v_cvt_pk_bf16_f32 v132, v104, v105
    v_exp_f32 v108, v108
    v_exp_f32 v109, v109
    v_cvt_pk_bf16_f32 v133, v106, v107
    v_mfma_f32_32x32x16_bf16 v[144:159], a[228:231], v[128:131], 0
    v_exp_f32 v110, v110
    v_exp_f32 v111, v111
    v_cvt_pk_bf16_f32 v134, v108, v109
    v_cvt_pk_bf16_f32 v135, v110, v111
    s_nop 1
    v_mfma_f32_32x32x16_bf16 v[144:159], a[232:235], v[132:135], v[144:159]
    s_waitcnt vmcnt(0)
    v_xor_b32 v73, v58, v48
    v_cmp_lt_u32 vcc, 15, v73
    s_nop 1
    s_cbranch_vccnz L_spin2
L_back3:
    s_cmp_ge_u32 s6, 4
    s_cselect_b32 s71, 2080768, 0
    s_add_u32 s71, s71, s70
    s_add_u32 s71, s71, 0
    s_cmp_lt_u32 s8, 4
    s_cbranch_scc1 L_kvs4
    buffer_load_dwordx4 a[128:131], v1, s[48:51], s71 offen offset:0 sc1
    buffer_load_dwordx4 a[140:143], v1, s[48:51], s71 offen offset:2048 sc1
    s_mov_b32 exec_lo, 0xffff
    s_mov_b32 exec_hi, 0xffff
    buffer_load_dwordx4 a[132:135], v60, s[48:51], s71 offen offset:1024 sc1
    buffer_load_dwordx4 a[136:139], v60, s[48:51], s71 offen offset:1536 sc1
    buffer_load_dwordx4 a[144:147], v60, s[48:51], s71 offen offset:3072 sc1
    buffer_load_dwordx4 a[148:151], v60, s[48:51], s71 offen offset:3584 sc1
    s_mov_b64 exec, -1
L_kvs4:
    s_cmp_ge_u32 s6, 3
    s_cselect_b32 s71, 2080768, 0
    s_add_u32 s71, s71, s70
    s_add_u32 s71, s71, 4096
    s_cmp_lt_u32 s8, 3
    s_cbranch_scc1 L_kvs5
    buffer_load_dwordx4 a[152:155], v1, s[48:51], s71 offen offset:0 sc1
    buffer_load_dwordx4 a[164:167], v1, s[48:51], s71 offen offset:2048 sc1
    s_mov_b32 exec_lo, 0xffff
    s_mov_b32 exec_hi, 0xffff
    buffer_load_dwordx4 a[156:159], v60, s[48:51], s71 offen offset:1024 sc1
    buffer_load_dwordx4 a[160:163], v60, s[48:51], s71 offen offset:1536 sc1
    buffer_load_dwordx4 a[168:171], v60, s[48:51], s71 offen offset:3072 sc1
    buffer_load_dwordx4 a[172:175], v60, s[48:51], s71 offen offset:3584 sc1
    s_mov_b64 exec, -1
L_kvs5:
    v_mfma_f32_32x32x16_bf16 v[96:111], a[236:239], a[252:255], v[176:191]
    v_exp_f32 v112, v112
    v_exp_f32 v113, v113
    v_exp_f32 v114, v114
    v_exp_f32 v115, v115
    v_cvt_pk_bf16_f32 v128, v112, v113
    v_exp_f32 v116, v116
    v_exp_f32 v117, v117
    v_cvt_pk_bf16_f32 v129, v114, v115
    v_exp_f32 v118, v118
    v_exp_f32 v119, v119
    v_cvt_pk_bf16_f32 v130, v116, v117
    v_exp_f32 v120, v120
    v_exp_f32 v121, v121
    v_cvt_pk_bf16_f32 v131, v118, v119
    v_exp_f32 v122, v122
    v_exp_f32 v123, v123
    v_cvt_pk_bf16_f32 v132, v120, v121
    v_exp_f32 v124, v124
    v_exp_f32 v125, v125
    v_cvt_pk_bf16_f32 v133, v122, v123
    v_mfma_f32_32x32x16_bf16 v[160:175], a[228:231], v[128:131], 0
    v_exp_f32 v126, v126
    v_exp_f32 v127, v127
    v_cvt_pk_bf16_f32 v134, v124, v125
    v_cvt_pk_bf16_f32 v135, v126, v127
    v_exp_f32 v96, v96
    v_exp_f32 v97, v97
    v_exp_f32 v98, v98
    v_exp_f32 v99, v99
    v_cvt_pk_bf16_f32 v128, v96, v97
    v_mfma_f32_32x32x16_bf16 v[160:175], a[232:235], v[132:135], v[160:175]
    v_exp_f32 v100, v100
    v_exp_f32 v101, v101
    v_cvt_pk_bf16_f32 v129, v98, v99
    v_exp_f32 v102, v102
    v_exp_f32 v103, v103
    v_cvt_pk_bf16_f32 v130, v100, v101
    v_exp_f32 v104, v104
    v_exp_f32 v105, v105
    v_cvt_pk_bf16_f32 v131, v102, v103
    v_exp_f32 v106, v106
    v_exp_f32 v107, v107
    v_cvt_pk_bf16_f32 v132, v104, v105
    v_exp_f32 v108, v108
    v_exp_f32 v109, v109
    v_cvt_pk_bf16_f32 v133, v106, v107
    v_mfma_f32_32x32x16_bf16 v[160:175], a[240:243], v[128:131], v[160:175]
    v_exp_f32 v110, v110
    v_exp_f32 v111, v111
    v_cvt_pk_bf16_f32 v134, v108, v109
    v_cvt_pk_bf16_f32 v135, v110, v111
    s_cmp_ge_u32 s6, 2
    s_cselect_b32 s71, 2080768, 0
    s_add_u32 s71, s71, s70
    s_add_u32 s71, s71, 8192
    s_cmp_lt_u32 s8, 2
    s_cbranch_scc1 L_kvs6
    buffer_load_dwordx4 a[176:179], v1, s[48:51], s71 offen offset:0 sc1
    buffer_load_dwordx4 a[188:191], v1, s[48:51], s71 offen offset:2048 sc1
    s_mov_b32 exec_lo, 0xffff
    s_mov_b32 exec_hi, 0xffff
    buffer_load_dwordx4 a[180:183], v60, s[48:51], s71 offen offset:1024 sc1
    buffer_load_dwordx4 a[184:187], v60, s[48:51], s71 offen offset:1536 sc1
    buffer_load_dwordx4 a[192:195], v60, s[48:51], s71 offen offset:3072 sc1
    buffer_load_dwordx4 a[196:199], v60, s[48:51], s71 offen offset:3584 sc1
    s_mov_b64 exec, -1
L_kvs6:
    s_waitcnt lgkmcnt(0)
    s_barrier
    s_waitcnt vmcnt(12)
    v_mfma_f32_32x32x16_bf16 v[112:127], a[128:131], a[248:251], v[192:207]
    v_mfma_f32_32x32x16_bf16 v[96:111], a[140:143], a[248:251], 0
    s_nop 10
    v_exp_f32 v112, v112
    v_exp_f32 v113, v113
    v_exp_f32 v114, v114
    v_exp_f32 v115, v115
    v_cvt_pk_bf16_f32 v128, v112, v113
    v_mfma_f32_32x32x16_bf16 v[160:175], a[244:247], v[132:135], v[160:175]
    s_cmp_ge_u32 s6, 1
    s_cselect_b32 s71, 2080768, 0
    s_add_u32 s71, s71, s70
    s_add_u32 s71, s71, 12288
    s_cmp_lt_u32 s8, 1
    s_cbranch_scc1 L_kvs7
    buffer_load_dwordx4 a[200:203], v1, s[48:51], s71 offen offset:0 sc1
    buffer_load_dwordx4 a[212:215], v1, s[48:51], s71 offen offset:2048 sc1
    s_mov_b32 exec_lo, 0xffff
    s_mov_b32 exec_hi, 0xffff
    buffer_load_dwordx4 a[204:207], v60, s[48:51], s71 offen offset:1024 sc1
    buffer_load_dwordx4 a[208:211], v60, s[48:51], s71 offen offset:1536 sc1
    buffer_load_dwordx4 a[216:219], v60, s[48:51], s71 offen offset:3072 sc1
    buffer_load_dwordx4 a[220:223], v60, s[48:51], s71 offen offset:3584 sc1
    s_mov_b64 exec, -1
L_kvs7:
    v_exp_f32 v116, v116
    v_exp_f32 v117, v117
    v_cvt_pk_bf16_f32 v129, v114, v115
    v_exp_f32 v118, v118
    v_exp_f32 v119, v119
    v_cvt_pk_bf16_f32 v130, v116, v117
    v_exp_f32 v120, v120
    v_exp_f32 v121, v121
    v_cvt_pk_bf16_f32 v131, v118, v119
    v_exp_f32 v122, v122
    v_exp_f32 v123, v123
    v_cvt_pk_bf16_f32 v132, v120, v121
    v_exp_f32 v124, v124
    v_exp_f32 v125, v125
    v_cvt_pk_bf16_f32 v133, v122, v123
    v_mfma_f32_32x32x16_bf16 v[144:159], a[132:135], v[128:131], v[144:159]
    v_exp_f32 v126, v126
    v_exp_f32 v127, v127
    v_cvt_pk_bf16_f32 v134, v124, v125
    v_cvt_pk_bf16_f32 v135, v126, v127
    v_mfma_f32_32x32x16_bf16 v[112:127], a[140:143], a[252:255], v[192:207]
    v_exp_f32 v96, v96
    v_exp_f32 v97, v97
    v_exp_f32 v98, v98
    v_exp_f32 v99, v99
    v_cvt_pk_bf16_f32 v128, v96, v97
    v_mfma_f32_32x32x16_bf16 v[144:159], a[136:139], v[132:135], v[144:159]
    v_exp_f32 v100, v100
    v_exp_f32 v101, v101
    v_cvt_pk_bf16_f32 v129, v98, v99
    v_exp_f32 v102, v102
    v_exp_f32 v103, v103
    v_cvt_pk_bf16_f32 v130, v100, v101
    v_exp_f32 v104, v104
    v_exp_f32 v105, v105
    v_cvt_pk_bf16_f32 v131, v102, v103
    v_exp_f32 v106, v106
    v_exp_f32 v107, v107
    v_cvt_pk_bf16_f32 v132, v104, v105
    v_exp_f32 v108, v108
    v_exp_f32 v109, v109
    v_cvt_pk_bf16_f32 v133, v106, v107
    v_mfma_f32_32x32x16_bf16 v[144:159], a[144:147], v[128:131], v[144:159]
    v_exp_f32 v110, v110
    v_exp_f32 v111, v111
    v_cvt_pk_bf16_f32 v134, v108, v109
    v_cvt_pk_bf16_f32 v135, v110, v111
    s_waitcnt vmcnt(12)
    v_mfma_f32_32x32x16_bf16 v[96:111], a[152:155], a[248:251], 0
    v_exp_f32 v112, v112
    v_exp_f32 v113, v113
    v_exp_f32 v114, v114
    v_exp_f32 v115, v115
    v_cvt_pk_bf16_f32 v128, v112, v113
    v_mfma_f32_32x32x16_bf16 v[144:159], a[148:151], v[132:135], v[144:159]
    buffer_load_dwordx2 v[64:65], v62, s[24:27], s20 offen offset:0
    v_exp_f32 v116, v116
    v_exp_f32 v117, v117
    v_cvt_pk_bf16_f32 v129, v114, v115
    buffer_load_dwordx2 v[66:67], v62, s[24:27], s20 offen offset:16
    v_exp_f32 v118, v118
    v_exp_f32 v119, v119
    v_cvt_pk_bf16_f32 v130, v116, v117
    buffer_load_dwordx2 v[68:69], v62, s[24:27], s20 offen offset:32
    v_exp_f32 v120, v120
    v_exp_f32 v121, v121
    v_cvt_pk_bf16_f32 v131, v118, v119
    buffer_load_dwordx2 v[70:71], v62, s[24:27], s20 offen offset:48
    v_exp_f32 v122, v122
    v_exp_f32 v123, v123
    v_cvt_pk_bf16_f32 v132, v120, v121
    buffer_load_dword v49, v56, s[48:51], 0 offen sc1
    v_exp_f32 v124, v124
    v_exp_f32 v125, v125
    v_cvt_pk_bf16_f32 v133, v122, v123
    v_mfma_f32_32x32x16_bf16 v[160:175], a[144:147], v[128:131], v[160:175]
    buffer_load_dword v72, v63, s[48:51], 0 offen sc1
    v_exp_f32 v126, v126
    v_exp_f32 v127, v127
    v_cvt_pk_bf16_f32 v134, v124, v125
    v_cvt_pk_bf16_f32 v135, v126, v127
    v_mfma_f32_32x32x16_bf16 v[112:127], a[152:155], a[252:255], 0
    v_exp_f32 v96, v96
    v_exp_f32 v97, v97
    v_exp_f32 v98, v98
    v_exp_f32 v99, v99
    v_cvt_pk_bf16_f32 v128, v96, v97
    v_mfma_f32_32x32x16_bf16 v[160:175], a[148:151], v[132:135], v[160:175]
    s_xor_b32 s91, s99, 0
    s_mul_i32 s91, s91, 229376
    s_add_u32 s91, s91, s22
    v_exp_f32 v100, v100
    v_exp_f32 v101, v101
    v_cvt_pk_bf16_f32 v129, v98, v99
    s_add_u32 m0, s13, 0
    s_nop 0
    buffer_load_dwordx4 v6, s[36:39], s91 offen offset:0 lds
    v_exp_f32 v102, v102
    v_exp_f32 v103, v103
    v_cvt_pk_bf16_f32 v130, v100, v101
    v_exp_f32 v104, v104
    v_exp_f32 v105, v105
    v_cvt_pk_bf16_f32 v131, v102, v103
    v_exp_f32 v106, v106
    v_exp_f32 v107, v107
    v_cvt_pk_bf16_f32 v132, v104, v105
    v_exp_f32 v108, v108
    v_exp_f32 v109, v109
    v_cvt_pk_bf16_f32 v133, v106, v107
    v_mfma_f32_32x32x16_bf16 v[144:159], a[156:159], v[128:131], v[144:159]
    v_exp_f32 v110, v110
    v_exp_f32 v111, v111
    v_cvt_pk_bf16_f32 v134, v108, v109
    v_cvt_pk_bf16_f32 v135, v110, v111
    v_mfma_f32_32x32x16_bf16 v[96:111], a[164:167], a[248:251], 0
    v_exp_f32 v112, v112
    v_exp_f32 v113, v113
    v_exp_f32 v114, v114
    v_exp_f32 v115, v115
    v_cvt_pk_bf16_f32 v128, v112, v113
    v_mfma_f32_32x32x16_bf16 v[144:159], a[160:163], v[132:135], v[144:159]
    buffer_load_dwordx4 v7, s[36:39], s91 offen offset:1024 lds
    v_exp_f32 v116, v116
    v_exp_f32 v117, v117
    v_cvt_pk_bf16_f32 v129, v114, v115
    v_exp_f32 v118, v118
    v_exp_f32 v119, v119
    v_cvt_pk_bf16_f32 v130, v116, v117
    v_exp_f32 v120, v120
    v_exp_f32 v121, v121
    v_cvt_pk_bf16_f32 v131, v118, v119
    v_exp_f32 v122, v122
    v_exp_f32 v123, v123
    v_cvt_pk_bf16_f32 v132, v120, v121
    v_exp_f32 v124, v124
    v_exp_f32 v125, v125
    v_cvt_pk_bf16_f32 v133, v122, v123
    v_mfma_f32_32x32x16_bf16 v[160:175], a[156:159], v[128:131], v[160:175]
    v_exp_f32 v126, v126
    v_exp_f32 v127, v127
    v_cvt_pk_bf16_f32 v134, v124, v125
    v_cvt_pk_bf16_f32 v135, v126, v127
    v_mfma_f32_32x32x16_bf16 v[112:127], a[164:167], a[252:255], 0
    v_exp_f32 v96, v96
    v_exp_f32 v97, v97
    v_exp_f32 v98, v98
    v_exp_f32 v99, v99
    v_cvt_pk_bf16_f32 v128, v96, v97
    v_mfma_f32_32x32x16_bf16 v[160:175], a[160:163], v[132:135], v[160:175]
    v_exp_f32 v100, v100
    v_exp_f32 v101, v101
    v_cvt_pk_bf16_f32 v129, v98, v99
    v_exp_f32 v102, v102
    v_exp_f32 v103, v103
    v_cvt_pk_bf16_f32 v130, v100, v101
    v_exp_f32 v104, v104
    v_exp_f32 v105, v105
    v_cvt_pk_bf16_f32 v131, v102, v103
    v_exp_f32 v106, v106
    v_exp_f32 v107, v107
    v_cvt_pk_bf16_f32 v132, v104, v105
    v_exp_f32 v108, v108
    v_exp_f32 v109, v109
    v_cvt_pk_bf16_f32 v133, v106, v107
    v_mfma_f32_32x32x16_bf16 v[144:159], a[168:171], v[128:131], v[144:159]
    v_exp_f32 v110, v110
    v_exp_f32 v111, v111
    v_cvt_pk_bf16_f32 v134, v108, v109
    v_cvt_pk_bf16_f32 v135, v110, v111
    s_waitcnt vmcnt(14)
    v_mfma_f32_32x32x16_bf16 v[96:111], a[176:179], a[248:251], 0
    v_exp_f32 v112, v112
    v_exp_f32 v113, v113
    v_exp_f32 v114, v114
    v_exp_f32 v115, v115
    v_cvt_pk_bf16_f32 v128, v112, v113
    v_mfma_f32_32x32x16_bf16 v[144:159], a[172:175], v[132:135], v[144:159]
    buffer_load_dwordx4 v8, s[36:39], s91 offen offset:2048 lds
    v_exp_f32 v116, v116
    v_exp_f32 v117, v117
    v_cvt_pk_bf16_f32 v129, v114, v115
    v_exp_f32 v118, v118
    v_exp_f32 v119, v119
    v_cvt_pk_bf16_f32 v130, v116, v117
    v_exp_f32 v120, v120
    v_exp_f32 v121, v121
    v_cvt_pk_bf16_f32 v131, v118, v119
    v_exp_f32 v122, v122
    v_exp_f32 v123, v123
    v_cvt_pk_bf16_f32 v132, v120, v121
    v_exp_f32 v124, v124
    v_exp_f32 v125, v125
    v_cvt_pk_bf16_f32 v133, v122, v123
    v_mfma_f32_32x32x16_bf16 v[160:175], a[168:171], v[128:131], v[160:175]
    v_exp_f32 v126, v126
    v_exp_f32 v127, v127
    v_cvt_pk_bf16_f32 v134, v124, v125
    v_cvt_pk_bf16_f32 v135, v126, v127
    v_mfma_f32_32x32x16_bf16 v[112:127], a[176:179], a[252:255], 0
    v_exp_f32 v96, v96
    v_exp_f32 v97, v97
    v_exp_f32 v98, v98
    v_exp_f32 v99, v99
    v_cvt_pk_bf16_f32 v128, v96, v97
    v_mfma_f32_32x32x16_bf16 v[160:175], a[172:175], v[132:135], v[160:175]
    buffer_load_dwordx4 v9, s[36:39], s91 offen offset:3072 lds
    v_exp_f32 v100, v100
    v_exp_f32 v101, v101
    v_cvt_pk_bf16_f32 v129, v98, v99
    v_exp_f32 v102, v102
    v_exp_f32 v103, v103
    v_cvt_pk_bf16_f32 v130, v100, v101
    v_exp_f32 v104, v104
    v_exp_f32 v105, v105
    v_cvt_pk_bf16_f32 v131, v102, v103
    v_exp_f32 v106, v106
    v_exp_f32 v107, v107
    v_cvt_pk_bf16_f32 v132, v104, v105
    v_exp_f32 v108, v108
    v_exp_f32 v109, v109
    v_cvt_pk_bf16_f32 v133, v106, v107
    v_mfma_f32_32x32x16_bf16 v[144:159], a[180:183], v[128:131], v[144:159]
    v_exp_f32 v110, v110
    v_exp_f32 v111, v111
    v_cvt_pk_bf16_f32 v134, v108, v109
    v_cvt_pk_bf16_f32 v135, v110, v111
    v_mfma_f32_32x32x16_bf16 v[96:111], a[188:191], a[248:251], 0
    v_exp_f32 v112, v112
    v_exp_f32 v113, v113
    v_exp_f32 v114, v114
    v_exp_f32 v115, v115
    v_cvt_pk_bf16_f32 v128, v112, v113
    v_mfma_f32_32x32x16_bf16 v[144:159], a[184:187], v[132:135], v[144:159]
    v_exp_f32 v116, v116
    v_exp_f32 v117, v117
    v_cvt_pk_bf16_f32 v129, v114, v115
    v_exp_f32 v118, v118
    v_exp_f32 v119, v119
    v_cvt_pk_bf16_f32 v130, v116, v117
    v_exp_f32 v120, v120
    v_exp_f32 v121, v121
    v_cvt_pk_bf16_f32 v131, v118, v119
    v_exp_f32 v122, v122
    v_exp_f32 v123, v123
    v_cvt_pk_bf16_f32 v132, v120, v121
    v_exp_f32 v124, v124
    v_exp_f32 v125, v125
    v_cvt_pk_bf16_f32 v133, v122, v123
    v_mfma_f32_32x32x16_bf16 v[160:175], a[180:183], v[128:131], v[160:175]
    v_exp_f32 v126, v126
    v_exp_f32 v127, v127
    v_cvt_pk_bf16_f32 v134, v124, v125
    v_cvt_pk_bf16_f32 v135, v126, v127
    v_mfma_f32_32x32x16_bf16 v[112:127], a[188:191], a[252:255], 0
    v_exp_f32 v96, v96
    v_exp_f32 v97, v97
    v_exp_f32 v98, v98
    v_exp_f32 v99, v99
    v_cvt_pk_bf16_f32 v128, v96, v97
    v_mfma_f32_32x32x16_bf16 v[160:175], a[184:187], v[132:135], v[160:175]
    v_exp_f32 v100, v100
    v_exp_f32 v101, v101
    v_cvt_pk_bf16_f32 v129, v98, v99
    v_exp_f32 v102, v102
    v_exp_f32 v103, v103
    v_cvt_pk_bf16_f32 v130, v100, v101
    v_exp_f32 v104, v104
    v_exp_f32 v105, v105
    v_cvt_pk_bf16_f32 v131, v102, v103
    v_exp_f32 v106, v106
    v_exp_f32 v107, v107
    v_cvt_pk_bf16_f32 v132, v104, v105
    v_exp_f32 v108, v108
    v_exp_f32 v109, v109
    v_cvt_pk_bf16_f32 v133, v106, v107
    v_mfma_f32_32x32x16_bf16 v[144:159], a[192:195], v[128:131], v[144:159]
    v_exp_f32 v110, v110
    v_exp_f32 v111, v111
    v_cvt_pk_bf16_f32 v134, v108, v109
    v_cvt_pk_bf16_f32 v135, v110, v111
    s_waitcnt vmcnt(10)
    v_mfma_f32_32x32x16_bf16 v[96:111], a[200:203], a[248:251], 0
    v_exp_f32 v112, v112
    v_exp_f32 v113, v113
    v_exp_f32 v114, v114
    v_exp_f32 v115, v115
    v_cvt_pk_bf16_f32 v128, v112, v113
    v_mfma_f32_32x32x16_bf16 v[144:159], a[196:199], v[132:135], v[144:159]
    v_exp_f32 v116, v116
    v_exp_f32 v117, v117
    v_cvt_pk_bf16_f32 v129, v114, v115
    v_exp_f32 v118, v118
    v_exp_f32 v119, v119
    v_cvt_pk_bf16_f32 v130, v116, v117
    v_exp_f32 v120, v120
    v_exp_f32 v121, v121
    v_cvt_pk_bf16_f32 v131, v118, v119
    v_exp_f32 v122, v122
    v_exp_f32 v123, v123
    v_cvt_pk_bf16_f32 v132, v120, v121
    v_exp_f32 v124, v124
    v_exp_f32 v125, v125
    v_cvt_pk_bf16_f32 v133, v122, v123
    v_mfma_f32_32x32x16_bf16 v[160:175], a[192:195], v[128:131], v[160:175]
    v_exp_f32 v126, v126
    v_exp_f32 v127, v127
    v_cvt_pk_bf16_f32 v134, v124, v125
    v_cvt_pk_bf16_f32 v135, v126, v127
    v_mfma_f32_32x32x16_bf16 v[112:127], a[200:203], a[252:255], 0
    v_exp_f32 v96, v96
    v_exp_f32 v97, v97
    v_exp_f32 v98, v98
    v_exp_f32 v99, v99
    v_cvt_pk_bf16_f32 v128, v96, v97
    v_mfma_f32_32x32x16_bf16 v[160:175], a[196:199], v[132:135], v[160:175]
    v_exp_f32 v100, v100
    v_exp_f32 v101, v101
    v_cvt_pk_bf16_f32 v129, v98, v99
    v_exp_f32 v102, v102
    v_exp_f32 v103, v103
    v_cvt_pk_bf16_f32 v130, v100, v101
    v_exp_f32 v104, v104
    v_exp_f32 v105, v105
    v_cvt_pk_bf16_f32 v131, v102, v103
    v_exp_f32 v106, v106
    v_exp_f32 v107, v107
    v_cvt_pk_bf16_f32 v132, v104, v105
    v_exp_f32 v108, v108
    v_exp_f32 v109, v109
    v_cvt_pk_bf16_f32 v133, v106, v107
    v_mfma_f32_32x32x16_bf16 v[144:159], a[204:207], v[128:131], v[144:159]
    v_exp_f32 v110, v110
    v_exp_f32 v111, v111
    v_cvt_pk_bf16_f32 v134, v108, v109
    v_cvt_pk_bf16_f32 v135, v110, v111
    v_mfma_f32_32x32x16_bf16 v[96:111], a[212:215], a[248:251], 0
    v_exp_f32 v112, v112
    v_exp_f32 v113, v113
    v_exp_f32 v114, v114
    v_exp_f32 v115, v115
    v_cvt_pk_bf16_f32 v128, v112, v113
    v_mfma_f32_32x32x16_bf16 v[144:159], a[208:211], v[132:135], v[144:159]
    v_exp_f32 v116, v116
    v_exp_f32 v117, v117
    v_cvt_pk_bf16_f32 v129, v114, v115
    v_exp_f32 v118, v118
    v_exp_f32 v119, v119
    v_cvt_pk_bf16_f32 v130, v116, v117
    v_exp_f32 v120, v120
    v_exp_f32 v121, v121
    v_cvt_pk_bf16_f32 v131, v118, v119
    v_exp_f32 v122, v122
    v_exp_f32 v123, v123
    v_cvt_pk_bf16_f32 v132, v120, v121
    v_exp_f32 v124, v124
    v_exp_f32 v125, v125
    v_cvt_pk_bf16_f32 v133, v122, v123
    v_mfma_f32_32x32x16_bf16 v[160:175], a[204:207], v[128:131], v[160:175]
    v_exp_f32 v126, v126
    v_exp_f32 v127, v127
    v_cvt_pk_bf16_f32 v134, v124, v125
    v_cvt_pk_bf16_f32 v135, v126, v127
    v_mfma_f32_32x32x16_bf16 v[112:127], a[212:215], a[252:255], 0
    v_exp_f32 v96, v96
    v_exp_f32 v97, v97
    v_exp_f32 v98, v98
    v_exp_f32 v99, v99
    v_cvt_pk_bf16_f32 v128, v96, v97
    v_mfma_f32_32x32x16_bf16 v[160:175], a[208:211], v[132:135], v[160:175]
    v_exp_f32 v100, v100
    v_exp_f32 v101, v101
    v_cvt_pk_bf16_f32 v129, v98, v99
    v_exp_f32 v102, v102
    v_exp_f32 v103, v103
    v_cvt_pk_bf16_f32 v130, v100, v101
    v_exp_f32 v104, v104
    v_exp_f32 v105, v105
    v_cvt_pk_bf16_f32 v131, v102, v103
    v_exp_f32 v106, v106
    v_exp_f32 v107, v107
    v_cvt_pk_bf16_f32 v132, v104, v105
    v_exp_f32 v108, v108
    v_exp_f32 v109, v109
    v_cvt_pk_bf16_f32 v133, v106, v107
    v_mfma_f32_32x32x16_bf16 v[144:159], a[216:219], v[128:131], v[144:159]
    v_exp_f32 v110, v110
    v_exp_f32 v111, v111
    v_cvt_pk_bf16_f32 v134, v108, v109
    v_cvt_pk_bf16_f32 v135, v110, v111
    v_exp_f32 v112, v112
    v_exp_f32 v113, v113
    v_exp_f32 v114, v114
    v_exp_f32 v115, v115
    v_cvt_pk_bf16_f32 v128, v112, v113
    v_mfma_f32_32x32x16_bf16 v[144:159], a[220:223], v[132:135], v[144:159]
    v_exp_f32 v116, v116
    v_exp_f32 v117, v117
    v_cvt_pk_bf16_f32 v129, v114, v115
    v_exp_f32 v118, v118
    v_exp_f32 v119, v119
    v_cvt_pk_bf16_f32 v130, v116, v117
    v_exp_f32 v120, v120
    v_exp_f32 v121, v121
    v_cvt_pk_bf16_f32 v131, v118, v119
    v_exp_f32 v122, v122
    v_exp_f32 v123, v123
    v_cvt_pk_bf16_f32 v132, v120, v121
    v_exp_f32 v124, v124
    v_exp_f32 v125, v125
    v_cvt_pk_bf16_f32 v133, v122, v123
    v_mfma_f32_32x32x16_bf16 v[160:175], a[216:219], v[128:131], v[160:175]
    v_exp_f32 v126, v126
    v_exp_f32 v127, v127
    v_cvt_pk_bf16_f32 v134, v124, v125
    v_cvt_pk_bf16_f32 v135, v126, v127
    s_nop 1
    v_mfma_f32_32x32x16_bf16 v[160:175], a[220:223], v[132:135], v[160:175]
    s_mov_b32 s90, 0
L_onorm:
    v_rcp_f32 v153, v152
    s_nop 0
    v_mul_f32 v144, v144, v153
    v_mul_f32 v145, v145, v153
    v_mul_f32 v146, v146, v153
    v_mul_f32 v147, v147, v153
    v_mul_f32 v148, v148, v153
    v_mul_f32 v149, v149, v153
    v_mul_f32 v150, v150, v153
    v_mul_f32 v151, v151, v153
    v_cvt_pk_bf16_f32 v136, v144, v145
    v_cvt_pk_bf16_f32 v137, v146, v147
    v_cvt_pk_bf16_f32 v138, v148, v149
    v_cvt_pk_bf16_f32 v139, v150, v151
    buffer_store_dwordx4 v[136:139], v1, s[48:51], s86 offen sc1
    v_rcp_f32 v169, v168
    s_nop 0
    v_mul_f32 v160, v160, v169
    v_mul_f32 v161, v161, v169
    v_mul_f32 v162, v162, v169
    v_mul_f32 v163, v163, v169
    v_mul_f32 v164, v164, v169
    v_mul_f32 v165, v165, v169
    v_mul_f32 v166, v166, v169
    v_mul_f32 v167, v167, v169
    v_cvt_pk_bf16_f32 v140, v160, v161
    v_cvt_pk_bf16_f32 v141, v162, v163
    v_cvt_pk_bf16_f32 v142, v164, v165
    v_cvt_pk_bf16_f32 v143, v166, v167
    buffer_store_dwordx4 v[140:143], v1, s[48:51], s87 offen sc1
    v_pk_add_f32 v[144:145], v[144:145], v[146:147]
    v_pk_add_f32 v[144:145], v[144:145], v[148:149]
    v_pk_add_f32 v[144:145], v[144:145], v[150:151]
    v_pk_add_f32 v[144:145], v[144:145], v[160:161]
    v_pk_add_f32 v[144:145], v[144:145], v[162:163]
    v_pk_add_f32 v[144:145], v[144:145], v[164:165]
    v_pk_add_f32 v[144:145], v[144:145], v[166:167]
    v_add_f32 v144, v144, v145
    s_mov_b32 s63, 0x2b800000
    s_mov_b32 s73, 2071986176
    v_cmp_class_f32 vcc, v144, v57
    v_cmp_nle_f32 s[74:75], s63, v152
    s_nop 1
    s_or_b64 vcc, vcc, s[74:75]
    v_cmp_nge_f32 s[74:75], s73, v152
    s_nop 1
    s_or_b64 vcc, vcc, s[74:75]
    v_cmp_nle_f32 s[74:75], s63, v168
    s_nop 1
    s_or_b64 vcc, vcc, s[74:75]
    v_cmp_nge_f32 s[74:75], s73, v168
    s_nop 1
    s_or_b64 vcc, vcc, s[74:75]
    s_cmp_lg_u32 s90, 0
    s_cbranch_scc1 L_ook
    s_cmp_lg_u64 vcc, 0
    s_cbranch_scc1 L_truemax
L_ook:
    s_waitcnt vmcnt(6)
    v_xor_b32 v73, v72, v48
    v_cmp_lt_u32 vcc, 15, v73
    s_nop 1
    s_cbranch_vccnz L_spin8
L_back9:
    v_cmp_ne_u32 vcc, s14, v72
    s_nop 1
    s_cmp_eq_u64 vcc, 0
    s_cselect_b32 s10, 1, 0
    s_lshl_b32 s63, s6, 7
    s_lshl_b32 s73, s12, 6
    s_add_u32 s63, s63, s73
    s_add_u32 s63, s63, 4112384
    v_and_b32 v54, 15, v0
    v_lshlrev_b32 v54, 2, v54
    v_add_u32 v61, s63, v54
    s_lshl_b32 s70, s15, 15
    s_lshl_b32 s63, s12, 14
    s_add_u32 s70, s70, s63
    s_add_u32 s70, s70, 2621440
    ds_read_b64_tr_b16 a[0:1], v52 offset:0
    ds_read_b64_tr_b16 a[2:3], v52 offset:1024
    ds_read_b64_tr_b16 a[4:5], v53 offset:0
    ds_read_b64_tr_b16 a[6:7], v53 offset:1024
    ds_read_b64_tr_b16 a[8:9], v52 offset:2048
    ds_read_b64_tr_b16 a[10:11], v52 offset:3072
    ds_read_b64_tr_b16 a[12:13], v53 offset:2048
    ds_read_b64_tr_b16 a[14:15], v53 offset:3072
    ds_read_b64_tr_b16 a[16:17], v52 offset:4096
    ds_read_b64_tr_b16 a[18:19], v52 offset:5120
    ds_read_b64_tr_b16 a[20:21], v53 offset:4096
    ds_read_b64_tr_b16 a[22:23], v53 offset:5120
    ds_read_b64_tr_b16 a[24:25], v52 offset:6144
    ds_read_b64_tr_b16 a[26:27], v52 offset:7168
    ds_read_b64_tr_b16 a[28:29], v53 offset:6144
    ds_read_b64_tr_b16 a[30:31], v53 offset:7168
    ds_read_b64_tr_b16 a[32:33], v52 offset:8192
    ds_read_b64_tr_b16 a[34:35], v52 offset:9216
    ds_read_b64_tr_b16 a[36:37], v53 offset:8192
    ds_read_b64_tr_b16 a[38:39], v53 offset:9216
    ds_read_b64_tr_b16 a[40:41], v52 offset:10240
    ds_read_b64_tr_b16 a[42:43], v52 offset:11264
    ds_read_b64_tr_b16 a[44:45], v53 offset:10240
    ds_read_b64_tr_b16 a[46:47], v53 offset:11264
    ds_read_b64_tr_b16 a[48:49], v52 offset:12288
    ds_read_b64_tr_b16 a[50:51], v52 offset:13312
    ds_read_b64_tr_b16 a[52:53], v53 offset:12288
    ds_read_b64_tr_b16 a[54:55], v53 offset:13312
    ds_read_b64_tr_b16 a[56:57], v52 offset:14336
    ds_read_b64_tr_b16 a[58:59], v52 offset:15360
    ds_read_b64_tr_b16 a[60:61], v53 offset:14336
    ds_read_b64_tr_b16 a[62:63], v53 offset:15360
    ds_read_b64_tr_b16 a[64:65], v52 offset:16384
    ds_read_b64_tr_b16 a[66:67], v52 offset:17408
    ds_read_b64_tr_b16 a[68:69], v53 offset:16384
    ds_read_b64_tr_b16 a[70:71], v53 offset:17408
    ds_read_b64_tr_b16 a[72:73], v52 offset:18432
    ds_read_b64_tr_b16 a[74:75], v52 offset:19456
    ds_read_b64_tr_b16 a[76:77], v53 offset:18432
    ds_read_b64_tr_b16 a[78:79], v53 offset:19456
    ds_read_b64_tr_b16 a[80:81], v52 offset:20480
    ds_read_b64_tr_b16 a[82:83], v52 offset:21504
    ds_read_b64_tr_b16 a[84:85], v53 offset:20480
    ds_read_b64_tr_b16 a[86:87], v53 offset:21504
    ds_read_b64_tr_b16 a[88:89], v52 offset:22528
    ds_read_b64_tr_b16 a[90:91], v52 offset:23552
    ds_read_b64_tr_b16 a[92:93], v53 offset:22528
    ds_read_b64_tr_b16 a[94:95], v53 offset:23552
    ds_read_b64_tr_b16 a[96:97], v52 offset:24576
    ds_read_b64_tr_b16 a[98:99], v52 offset:25600
    ds_read_b64_tr_b16 a[100:101], v53 offset:24576
    ds_read_b64_tr_b16 a[102:103], v53 offset:25600
    ds_read_b64_tr_b16 a[104:105], v52 offset:26624
    ds_read_b64_tr_b16 a[106:107], v52 offset:27648
    ds_read_b64_tr_b16 a[108:109], v53 offset:26624
    ds_read_b64_tr_b16 a[110:111], v53 offset:27648
    ds_read_b64_tr_b16 a[112:113], v52 offset:28672
    ds_read_b64_tr_b16 a[114:115], v52 offset:29696
    ds_read_b64_tr_b16 a[116:117], v53 offset:28672
    ds_read_b64_tr_b16 a[118:119], v53 offset:29696
    ds_read_b64_tr_b16 a[120:121], v52 offset:30720
    ds_read_b64_tr_b16 a[122:123], v52 offset:31744
    ds_read_b64_tr_b16 a[124:125], v53 offset:30720
    ds_read_b64_tr_b16 a[126:127], v53 offset:31744
    s_waitcnt vmcnt(0)
    s_cmp_lg_u32 s10, 0
    s_cbranch_scc1 L_pf10
    buffer_wbl2 sc1
    s_waitcnt vmcnt(0)
    buffer_store_dword v48, off, s[48:51], s89 sc1
    s_branch L_pd11
L_pf10:
    buffer_store_dword v48, off, s[48:51], s89
L_pd11:
    v_lshlrev_b32 v32, 16, v64
    v_and_b32 v33, s66, v64
    v_lshlrev_b32 v34, 16, v65
    v_and_b32 v35, s66, v65
    v_lshlrev_b32 v36, 16, v66
    v_and_b32 v37, s66, v66
    v_lshlrev_b32 v38, 16, v67
    v_and_b32 v39, s66, v67
    v_lshlrev_b32 v40, 16, v68
    v_and_b32 v41, s66, v68
    v_lshlrev_b32 v42, 16, v69
    v_and_b32 v43, s66, v69
    v_lshlrev_b32 v44, 16, v70
    v_and_b32 v45, s66, v70
    v_lshlrev_b32 v46, 16, v71
    v_and_b32 v47, s66, v71
    v_bfe_u32 v52, v0, 4, 1
    v_lshlrev_b32 v63, 2, v54
    v_lshl_add_u32 v63, v52, 3, v63
    v_lshrrev_b32 v53, 5, v0
    v_lshl_add_u32 v63, v53, 11, v63
    s_lshl_b32 s65, s15, 12
    s_lshl1_add_u32 s65, s94, s65
    s_lshl2_add_u32 s65, s12, s65
    s_add_u32 s65, s65, 4063232
    s_lshl_b32 s72, s15, 7
    s_lshl3_add_u32 s72, s7, s72
    s_lshl2_add_u32 s72, s12, s72
    s_add_u32 s72, s72, 4113408
    s_mov_b32 s60, 0
L_poll12:
    buffer_load_dword v50, v61, s[48:51], 0 offen sc1
    s_add_u32 s60, s60, 1
    s_cmp_gt_u32 s60, 262144
    s_waitcnt vmcnt(0)
    s_cbranch_scc1 L_pollx13
    v_xor_b32 v51, v50, v48
    v_cmp_lt_u32 vcc, 15, v51
    s_nop 1
    s_cbranch_vccnz L_poll12
L_pollx13:
    s_cmp_lg_u32 s10, 0
    s_cbranch_scc1 L_aq14
    buffer_inv sc1
    s_waitcnt vmcnt(0)
L_aq14:
    buffer_load_dwordx4 a[128:131], v1, s[48:51], s70 offen offset:0 sc1
    buffer_load_dwordx4 a[132:135], v1, s[48:51], s70 offen offset:1024 sc1
    buffer_load_dwordx4 a[136:139], v1, s[48:51], s70 offen offset:2048 sc1
    buffer_load_dwordx4 a[140:143], v1, s[48:51], s70 offen offset:3072 sc1
    s_add_u32 s70, s70, 4096
    buffer_load_dwordx4 a[144:147], v1, s[48:51], s70 offen offset:0 sc1
    buffer_load_dwordx4 a[148:151], v1, s[48:51], s70 offen offset:1024 sc1
    buffer_load_dwordx4 a[152:155], v1, s[48:51], s70 offen offset:2048 sc1
    buffer_load_dwordx4 a[156:159], v1, s[48:51], s70 offen offset:3072 sc1
    s_waitcnt lgkmcnt(0)
    s_add_u32 s63, s13, 147456
    v_add_u32 v52, s63, v1
    v_xor_b32 v53, 0x2000, v52
    s_waitcnt vmcnt(7)
    v_mfma_f32_32x32x16_bf16 v[80:95], a[4:7], a[128:131], 0
    v_mfma_f32_32x32x16_bf16 v[32:47], a[0:3], a[128:131], v[32:47]
    s_add_u32 s70, s70, 4096
    buffer_load_dwordx4 a[160:163], v1, s[48:51], s70 offen offset:0 sc1
    s_waitcnt vmcnt(7)
    v_mfma_f32_32x32x16_bf16 v[80:95], a[12:15], a[132:135], v[80:95]
    v_mfma_f32_32x32x16_bf16 v[32:47], a[8:11], a[132:135], v[32:47]
    buffer_load_dwordx4 a[164:167], v1, s[48:51], s70 offen offset:1024 sc1
    s_waitcnt vmcnt(7)
    v_mfma_f32_32x32x16_bf16 v[80:95], a[20:23], a[136:139], v[80:95]
    v_mfma_f32_32x32x16_bf16 v[32:47], a[16:19], a[136:139], v[32:47]
    buffer_load_dwordx4 a[168:171], v1, s[48:51], s70 offen offset:2048 sc1
    s_waitcnt vmcnt(7)
    v_mfma_f32_32x32x16_bf16 v[80:95], a[28:31], a[140:143], v[80:95]
    v_mfma_f32_32x32x16_bf16 v[32:47], a[24:27], a[140:143], v[32:47]
    buffer_load_dwordx4 a[172:175], v1, s[48:51], s70 offen offset:3072 sc1
    s_waitcnt vmcnt(7)
    v_mfma_f32_32x32x16_bf16 v[80:95], a[36:39], a[144:147], v[80:95]
    v_mfma_f32_32x32x16_bf16 v[32:47], a[32:35], a[144:147], v[32:47]
    s_add_u32 s70, s70, 4096
    buffer_load_dwordx4 a[176:179], v1, s[48:51], s70 offen offset:0 sc1
    s_waitcnt vmcnt(7)
    v_mfma_f32_32x32x16_bf16 v[80:95], a[44:47], a[148:151], v[80:95]
    v_mfma_f32_32x32x16_bf16 v[32:47], a[40:43], a[148:151], v[32:47]
    buffer_load_dwordx4 a[180:183], v1, s[48:51], s70 offen offset:1024 sc1
    s_waitcnt vmcnt(7)
    v_mfma_f32_32x32x16_bf16 v[80:95], a[52:55], a[152:155], v[80:95]
    v_mfma_f32_32x32x16_bf16 v[32:47], a[48:51], a[152:155], v[32:47]
    buffer_load_dwordx4 a[184:187], v1, s[48:51], s70 offen offset:2048 sc1
    s_waitcnt vmcnt(7)
    v_mfma_f32_32x32x16_bf16 v[80:95], a[60:63], a[156:159], v[80:95]
    v_mfma_f32_32x32x16_bf16 v[32:47], a[56:59], a[156:159], v[32:47]
    buffer_load_dwordx4 a[188:191], v1, s[48:51], s70 offen offset:3072 sc1
    s_waitcnt vmcnt(7)
    v_mfma_f32_32x32x16_bf16 v[80:95], a[68:71], a[160:163], v[80:95]
    v_mfma_f32_32x32x16_bf16 v[32:47], a[64:67], a[160:163], v[32:47]
    s_xor_b32 s91, s99, 1
    s_mul_i32 s91, s91, 229376
    s_add_u32 s91, s91, s22
    s_add_u32 m0, s13, 16384
    s_nop 0
    buffer_load_dwordx4 v6, s[36:39], s91 offen offset:0 lds
    s_waitcnt vmcnt(7)
    v_mfma_f32_32x32x16_bf16 v[80:95], a[76:79], a[164:167], v[80:95]
    v_mfma_f32_32x32x16_bf16 v[32:47], a[72:75], a[164:167], v[32:47]
    buffer_load_dwordx4 v7, s[36:39], s91 offen offset:1024 lds
    s_waitcnt vmcnt(7)
    v_mfma_f32_32x32x16_bf16 v[80:95], a[84:87], a[168:171], v[80:95]
    buffer_load_dwordx4 v8, s[36:39], s91 offen offset:2048 lds
    s_waitcnt vmcnt(7)
    v_mfma_f32_32x32x16_bf16 v[80:95], a[92:95], a[172:175], v[80:95]
    buffer_load_dwordx4 v9, s[36:39], s91 offen offset:3072 lds
    s_waitcnt vmcnt(7)
    v_mfma_f32_32x32x16_bf16 v[80:95], a[100:103], a[176:179], v[80:95]
    s_xor_b32 s91, s99, 2
    s_mul_i32 s91, s91, 229376
    s_add_u32 s91, s91, s22
    s_add_u32 m0, s13, 32768
    s_nop 0
    buffer_load_dwordx4 v6, s[36:39], s91 offen offset:0 lds
    s_waitcnt vmcnt(7)
    v_mfma_f32_32x32x16_bf16 v[80:95], a[108:111], a[180:183], v[80:95]
    buffer_load_dwordx4 v7, s[36:39], s91 offen offset:1024 lds
    s_waitcnt vmcnt(7)
    v_mfma_f32_32x32x16_bf16 v[80:95], a[116:119], a[184:187], v[80:95]
    buffer_load_dwordx4 v8, s[36:39], s91 offen offset:2048 lds
    s_waitcnt vmcnt(7)
    v_mfma_f32_32x32x16_bf16 v[80:95], a[124:127], a[188:191], v[80:95]
    buffer_load_dwordx4 v9, s[36:39], s91 offen offset:3072 lds
    v_mfma_f32_32x32x16_bf16 v[32:47], a[80:83], a[168:171], v[32:47]
    v_mfma_f32_32x32x16_bf16 v[32:47], a[88:91], a[172:175], v[32:47]
    v_mfma_f32_32x32x16_bf16 v[32:47], a[96:99], a[176:179], v[32:47]
    s_nop 7
    ds_write_b128 v52, v[80:83] offset:0
    v_mfma_f32_32x32x16_bf16 v[32:47], a[104:107], a[180:183], v[32:47]
    ds_write_b128 v52, v[84:87] offset:1024
    v_mfma_f32_32x32x16_bf16 v[32:47], a[112:115], a[184:187], v[32:47]
    ds_write_b128 v52, v[88:91] offset:2048
    v_mfma_f32_32x32x16_bf16 v[32:47], a[120:123], a[188:191], v[32:47]
    ds_write_b128 v52, v[92:95] offset:3072
    s_waitcnt lgkmcnt(0)
    s_barrier
    ds_read_b128 v[96:99], v53 offset:0
    ds_read_b128 v[100:103], v53 offset:1024
    ds_read_b128 v[104:107], v53 offset:2048
    ds_read_b128 v[108:111], v53 offset:3072
    s_waitcnt lgkmcnt(2)
    s_nop 3
    v_pk_add_f32 v[32:33], v[32:33], v[96:97]
    v_pk_add_f32 v[34:35], v[34:35], v[98:99]
    v_pk_add_f32 v[36:37], v[36:37], v[100:101]
    v_pk_add_f32 v[38:39], v[38:39], v[102:103]
    v_cvt_pk_bf16_f32 v112, v32, v33
    v_cvt_pk_bf16_f32 v113, v34, v35
    v_cvt_pk_bf16_f32 v114, v36, v37
    v_cvt_pk_bf16_f32 v115, v38, v39
    buffer_store_dwordx4 v[112:115], v1, s[48:51], s64 offen offset:0 sc1
    s_waitcnt lgkmcnt(0)
    v_pk_add_f32 v[40:41], v[40:41], v[104:105]
    v_pk_add_f32 v[42:43], v[42:43], v[106:107]
    v_pk_add_f32 v[44:45], v[44:45], v[108:109]
    v_pk_add_f32 v[46:47], v[46:47], v[110:111]
    v_cvt_pk_bf16_f32 v116, v40, v41
    v_cvt_pk_bf16_f32 v117, v42, v43
    v_cvt_pk_bf16_f32 v118, v44, v45
    v_cvt_pk_bf16_f32 v119, v46, v47
    buffer_store_dwordx4 v[116:119], v1, s[48:51], s64 offen offset:1024 sc1
    v_pk_add_f32 v[120:121], v[32:33], v[34:35]
    v_pk_mul_f32 v[122:123], v[32:33], v[32:33]
    v_pk_fma_f32 v[122:123], v[34:35], v[34:35], v[122:123]
    v_pk_add_f32 v[120:121], v[120:121], v[36:37]
    v_pk_fma_f32 v[122:123], v[36:37], v[36:37], v[122:123]
    v_pk_add_f32 v[120:121], v[120:121], v[38:39]
    v_pk_fma_f32 v[122:123], v[38:39], v[38:39], v[122:123]
    v_pk_add_f32 v[120:121], v[120:121], v[40:41]
    v_pk_fma_f32 v[122:123], v[40:41], v[40:41], v[122:123]
    v_pk_add_f32 v[120:121], v[120:121], v[42:43]
    v_pk_fma_f32 v[122:123], v[42:43], v[42:43], v[122:123]
    v_pk_add_f32 v[120:121], v[120:121], v[44:45]
    v_pk_fma_f32 v[122:123], v[44:45], v[44:45], v[122:123]
    v_pk_add_f32 v[120:121], v[120:121], v[46:47]
    v_pk_fma_f32 v[122:123], v[46:47], v[46:47], v[122:123]
    v_add_f32 v120, v120, v121
    v_add_f32 v122, v122, v123
    s_nop 1
    v_permlane32_swap_b32 v120, v122
    v_add_f32 v120, v120, v122
    buffer_store_dword v120, v63, s[48:51], s65 offen
    s_mul_i32 s63, s12, 14
    s_add_u32 s23, s63, s19
    s_sub_u32 s80, s63, s19
    s_add_u32 s80, s80, 1
    s_lshl_b32 s81, s23, 12
    s_lshl_b32 s82, s80, 12
    s_lshl_b32 s83, s23, 2
    s_lshl_b32 s84, s80, 2
    s_lshl_b32 s63, s11, 15
    s_add_u32 s63, s63, s94
    s_lshl_b32 s23, s23, 16
    s_add_u32 s23, s23, s63
    s_lshl_b32 s80, s80, 16
    s_add_u32 s80, s80, s63
    v_mov_b32 v52, s15
    v_mov_b32 v53, s18
    v_cmp_gt_u32 vcc, 32, v0
    s_nop 1
    v_cndmask_b32 v52, v52, v53, vcc
    v_mov_b32 v53, s17
    v_cmp_gt_u32 vcc, 16, v0
    s_nop 1
    v_cndmask_b32 v52, v52, v53, vcc
    v_lshl_add_u32 v52, v52, 7, v54
    v_add_u32 v55, 4113408, v52
    v_and_b32 v52, 31, v0
    v_mov_b32 v232, 0
    v_mov_b32 v233, 0
    v_mov_b32 v234, 0
    v_mov_b32 v235, 0
    v_mov_b32 v236, 0
    v_mov_b32 v237, 0
    v_mov_b32 v238, 0
    v_mov_b32 v239, 0
    v_mov_b32 v240, 0
    v_mov_b32 v241, 0
    v_mov_b32 v242, 0
    v_mov_b32 v243, 0
    v_mov_b32 v244, 0
    v_mov_b32 v245, 0
    v_mov_b32 v246, 0
    v_mov_b32 v247, 0
    v_mov_b32 v248, 0
    v_mov_b32 v249, 0
    s_lshl_b32 s63, s3, 7
    s_add_u32 s63, s63, 147456
    v_lshl_add_u32 v59, v52, 2, s63
    v_lshrrev_b32 v52, 2, v0
    v_xor_b32 v52, v52, v0
    v_bfe_u32 v52, v52, 2, 1
    v_subrev_u32 v52, 1, v52
    v_and_b32 v228, 1065369472, v52
    v_mov_b32 v229, v228
    v_mov_b32 v230, v228
    v_mov_b32 v231, v228
    v_min_u32 v52, 6, v0
    v_lshlrev_b32 v52, 3, v52
    s_lshl_b32 s63, s15, 7
    s_add_u32 s63, s63, 4114432
    s_add_u32 s83, s83, s63
    s_add_u32 s84, s84, s63
    v_add_u32 v57, s83, v52
    s_waitcnt vmcnt(0)
    s_cmp_lg_u32 s10, 0
    s_cbranch_scc1 L_pf15
    buffer_wbl2 sc1
    s_waitcnt vmcnt(0)
    buffer_store_dword v48, off, s[48:51], s72 sc1
    s_branch L_pd16
L_pf15:
    buffer_store_dword v48, off, s[48:51], s72
L_pd16:
    v_add_u32 v58, s84, v52
    s_mul_i32 s63, s15, 114688
    s_add_u32 s63, s63, 3145728
    s_add_u32 s81, s81, s63
    s_add_u32 s82, s82, s63
    s_mul_i32 s87, s17, 114688
    s_lshl_b32 s63, s5, 12
    s_add_u32 s87, s87, s63
    s_add_u32 s87, s87, 3145728
    s_lshl_b32 s63, s3, 10
    s_add_u32 s87, s87, s63
    s_lshl_b32 s89, s17, 7
    s_lshl_b32 s63, s5, 2
    s_add_u32 s89, s89, s63
    s_add_u32 s89, s89, 4114432
    s_lshl_b32 s97, s17, 15
    s_add_u32 s97, s97, 2883584
    s_lshl_b32 s63, s99, 12
    s_add_u32 s97, s97, s63
    s_mul_i32 s88, s18, 114688
    s_lshl_b32 s63, s5, 12
    s_add_u32 s88, s88, s63
    s_add_u32 s88, s88, 3145728
    s_lshl_b32 s63, s3, 10
    s_add_u32 s88, s88, s63
    s_lshl_b32 s90, s18, 7
    s_lshl_b32 s63, s5, 2
    s_add_u32 s90, s90, s63
    s_add_u32 s90, s90, 4114432
    s_lshl_b32 s98, s18, 15
    s_add_u32 s98, s98, 2883584
    s_lshl_b32 s63, s99, 12
    s_add_u32 s98, s98, s63
    s_barrier
    ds_read_b64_tr_b16 v[192:193], v17 offset:0
    ds_read_b64_tr_b16 v[194:195], v17 offset:1024
    ds_read_b64_tr_b16 v[196:197], v17 offset:2048
    ds_read_b64_tr_b16 v[198:199], v17 offset:3072
    ds_read_b64_tr_b16 v[200:201], v17 offset:4096
    ds_read_b64_tr_b16 v[202:203], v17 offset:5120
    ds_read_b64_tr_b16 v[204:205], v17 offset:6144
    ds_read_b64_tr_b16 v[206:207], v17 offset:7168
    ds_read_b64_tr_b16 v[208:209], v17 offset:16384
    ds_read_b64_tr_b16 v[210:211], v17 offset:17408
    s_waitcnt lgkmcnt(8)
    v_mfma_f32_16x16x32_bf16 v[224:227], v[228:231], v[192:195], 0
    ds_read_b64_tr_b16 v[212:213], v17 offset:18432
    ds_read_b64_tr_b16 v[214:215], v17 offset:19456
    s_waitcnt lgkmcnt(8)
    v_mfma_f32_16x16x32_bf16 v[224:227], v[228:231], v[196:199], v[224:227]
    ds_read_b64_tr_b16 v[216:217], v17 offset:20480
    ds_read_b64_tr_b16 v[218:219], v17 offset:21504
    s_waitcnt lgkmcnt(8)
    v_mfma_f32_16x16x32_bf16 v[224:227], v[228:231], v[200:203], v[224:227]
    ds_read_b64_tr_b16 v[220:221], v17 offset:22528
    ds_read_b64_tr_b16 v[222:223], v17 offset:23552
    s_waitcnt lgkmcnt(8)
    v_mfma_f32_16x16x32_bf16 v[224:227], v[228:231], v[204:207], v[224:227]
    ds_read_b64_tr_b16 v[192:193], v17 offset:32768
    ds_read_b64_tr_b16 v[194:195], v17 offset:33792
    s_waitcnt lgkmcnt(8)
    v_mfma_f32_16x16x32_bf16 v[224:227], v[228:231], v[208:211], v[224:227]
    ds_read_b64_tr_b16 v[196:197], v17 offset:34816
    ds_read_b64_tr_b16 v[198:199], v17 offset:35840
    s_waitcnt lgkmcnt(8)
    v_mfma_f32_16x16x32_bf16 v[224:227], v[228:231], v[212:215], v[224:227]
    ds_read_b64_tr_b16 v[200:201], v17 offset:36864
    ds_read_b64_tr_b16 v[202:203], v17 offset:37888
    s_waitcnt lgkmcnt(8)
    v_mfma_f32_16x16x32_bf16 v[224:227], v[228:231], v[216:219], v[224:227]
    ds_read_b64_tr_b16 v[204:205], v17 offset:38912
    ds_read_b64_tr_b16 v[206:207], v17 offset:39936
    s_waitcnt lgkmcnt(8)
    v_mfma_f32_16x16x32_bf16 v[224:227], v[228:231], v[220:223], v[224:227]
    s_waitcnt lgkmcnt(6)
    v_mfma_f32_16x16x32_bf16 v[224:227], v[228:231], v[192:195], v[224:227]
    s_waitcnt lgkmcnt(4)
    v_mfma_f32_16x16x32_bf16 v[224:227], v[228:231], v[196:199], v[224:227]
    s_waitcnt lgkmcnt(2)
    v_mfma_f32_16x16x32_bf16 v[224:227], v[228:231], v[200:203], v[224:227]
    s_waitcnt lgkmcnt(0)
    v_mfma_f32_16x16x32_bf16 v[224:227], v[228:231], v[204:207], v[224:227]
    ds_read_b64_tr_b16 v[192:193], v17 offset:0
    ds_read_b64_tr_b16 v[194:195], v17 offset:1024
    ds_read_b64_tr_b16 v[196:197], v18 offset:0
    ds_read_b64_tr_b16 v[198:199], v18 offset:1024
    ds_read_b64_tr_b16 v[200:201], v19 offset:0
    ds_read_b64_tr_b16 v[202:203], v19 offset:1024
    ds_read_b64_tr_b16 v[204:205], v20 offset:0
    ds_read_b64_tr_b16 v[206:207], v20 offset:1024
    s_mov_b32 s60, 0
L_poll17:
    buffer_load_dword v50, v55, s[48:51], 0 offen sc1
    s_add_u32 s60, s60, 1
    s_cmp_gt_u32 s60, 262144
    s_waitcnt vmcnt(0)
    s_cbranch_scc1 L_pollx18
    v_xor_b32 v51, v50, v48
    v_cmp_lt_u32 vcc, 15, v51
    s_nop 1
    s_cbranch_vccnz L_poll17
L_pollx18:
    s_cmp_lg_u32 s10, 0
    s_cbranch_scc1 L_aq19
    buffer_inv sc1
    s_waitcnt vmcnt(0)
L_aq19:
    s_cmp_ge_u32 s5, 28
    s_cbranch_scc1 L_spare
    s_xor_b32 s70, s97, 0
    buffer_load_dwordx4 a[0:3], v1, s[48:51], s70 offen offset:0 sc1
    s_xor_b32 s71, s98, 0
    buffer_load_dwordx4 a[128:131], v1, s[48:51], s71 offen offset:0 sc1
    buffer_load_dwordx4 a[4:7], v1, s[48:51], s70 offen offset:1024 sc1
    buffer_load_dwordx4 a[132:135], v1, s[48:51], s71 offen offset:1024 sc1
    buffer_load_dwordx4 a[8:11], v1, s[48:51], s70 offen offset:2048 sc1
    buffer_load_dwordx4 a[136:139], v1, s[48:51], s71 offen offset:2048 sc1
    buffer_load_dwordx4 a[12:15], v1, s[48:51], s70 offen offset:3072 sc1
    buffer_load_dwordx4 a[140:143], v1, s[48:51], s71 offen offset:3072 sc1
    s_waitcnt vmcnt(7) lgkmcnt(6)
    v_mfma_f32_32x32x16_bf16 v[64:79], v[192:195], a[0:3], 0
    s_waitcnt vmcnt(6)
    s_xor_b32 s91, s99, 3
    s_mul_i32 s91, s91, 229376
    s_add_u32 s91, s91, s22
    s_add_u32 m0, s13, 49152
    s_nop 0
    buffer_load_dwordx4 v6, s[36:39], s91 offen offset:0 lds
    v_mfma_f32_32x32x16_bf16 v[128:143], v[192:195], a[128:131], 0
    s_waitcnt lgkmcnt(4)
    s_xor_b32 s70, s97, 4096
    v_mfma_f32_32x32x16_bf16 v[80:95], v[196:199], a[0:3], 0
    v_mfma_f32_32x32x16_bf16 v[144:159], v[196:199], a[128:131], 0
    s_waitcnt lgkmcnt(2)
    buffer_load_dwordx4 a[16:19], v1, s[48:51], s70 offen offset:0 sc1
    s_xor_b32 s71, s98, 4096
    v_mfma_f32_32x32x16_bf16 v[96:111], v[200:203], a[0:3], 0
    ds_read_b64_tr_b16 v[208:209], v17 offset:2048
    ds_read_b64_tr_b16 v[210:211], v17 offset:3072
    v_mfma_f32_32x32x16_bf16 v[160:175], v[200:203], a[128:131], 0
    s_waitcnt lgkmcnt(2)
    buffer_load_dwordx4 a[144:147], v1, s[48:51], s71 offen offset:0 sc1
    v_mfma_f32_32x32x16_bf16 v[112:127], v[204:207], a[0:3], 0
    ds_read_b64_tr_b16 v[212:213], v18 offset:2048
    ds_read_b64_tr_b16 v[214:215], v18 offset:3072
    v_mfma_f32_32x32x16_bf16 v[176:191], v[204:207], a[128:131], 0
    s_waitcnt vmcnt(8) lgkmcnt(2)
    buffer_load_dwordx4 v7, s[36:39], s91 offen offset:1024 lds
    v_mfma_f32_32x32x16_bf16 v[64:79], v[208:211], a[4:7], v[64:79]
    s_waitcnt vmcnt(8)
    ds_read_b64_tr_b16 v[216:217], v19 offset:2048
    ds_read_b64_tr_b16 v[218:219], v19 offset:3072
    v_mfma_f32_32x32x16_bf16 v[128:143], v[208:211], a[132:135], v[128:143]
    s_waitcnt lgkmcnt(2)
    buffer_load_dwordx4 a[20:23], v1, s[48:51], s70 offen offset:1024 sc1
    v_mfma_f32_32x32x16_bf16 v[80:95], v[212:215], a[4:7], v[80:95]
    ds_read_b64_tr_b16 v[220:221], v20 offset:2048
    ds_read_b64_tr_b16 v[222:223], v20 offset:3072
    v_mfma_f32_32x32x16_bf16 v[144:159], v[212:215], a[132:135], v[144:159]
    s_waitcnt lgkmcnt(2)
    buffer_load_dwordx4 a[148:151], v1, s[48:51], s71 offen offset:1024 sc1
    v_mfma_f32_32x32x16_bf16 v[96:111], v[216:219], a[4:7], v[96:111]
    ds_read_b64_tr_b16 v[192:193], v17 offset:4096
    ds_read_b64_tr_b16 v[194:195], v17 offset:5120
    v_mfma_f32_32x32x16_bf16 v[160:175], v[216:219], a[132:135], v[160:175]
    s_waitcnt lgkmcnt(2)
    buffer_load_dwordx4 a[24:27], v1, s[48:51], s70 offen offset:2048 sc1
    v_mfma_f32_32x32x16_bf16 v[112:127], v[220:223], a[4:7], v[112:127]
    ds_read_b64_tr_b16 v[196:197], v18 offset:4096
    ds_read_b64_tr_b16 v[198:199], v18 offset:5120
    buffer_load_dwordx4 v8, s[36:39], s91 offen offset:2048 lds
    v_mfma_f32_32x32x16_bf16 v[176:191], v[220:223], a[132:135], v[176:191]
    s_waitcnt vmcnt(11) lgkmcnt(2)
    v_mfma_f32_32x32x16_bf16 v[64:79], v[192:195], a[8:11], v[64:79]
    s_waitcnt vmcnt(10)
    ds_read_b64_tr_b16 v[200:201], v19 offset:4096
    ds_read_b64_tr_b16 v[202:203], v19 offset:5120
    buffer_load_dwordx4 a[152:155], v1, s[48:51], s71 offen offset:2048 sc1
    v_mfma_f32_32x32x16_bf16 v[128:143], v[192:195], a[136:139], v[128:143]
    s_waitcnt lgkmcnt(2)
    v_mfma_f32_32x32x16_bf16 v[80:95], v[196:199], a[8:11], v[80:95]
    ds_read_b64_tr_b16 v[204:205], v20 offset:4096
    ds_read_b64_tr_b16 v[206:207], v20 offset:5120
    buffer_load_dwordx4 a[28:31], v1, s[48:51], s70 offen offset:3072 sc1
    v_mfma_f32_32x32x16_bf16 v[144:159], v[196:199], a[136:139], v[144:159]
    s_waitcnt lgkmcnt(2)
    v_mfma_f32_32x32x16_bf16 v[96:111], v[200:203], a[8:11], v[96:111]
    ds_read_b64_tr_b16 v[208:209], v17 offset:6144
    ds_read_b64_tr_b16 v[210:211], v17 offset:7168
    buffer_load_dwordx4 a[156:159], v1, s[48:51], s71 offen offset:3072 sc1
    s_xor_b32 s70, s97, 8192
    v_mfma_f32_32x32x16_bf16 v[160:175], v[200:203], a[136:139], v[160:175]
    s_waitcnt lgkmcnt(2)
    buffer_load_dwordx4 v9, s[36:39], s91 offen offset:3072 lds
    v_mfma_f32_32x32x16_bf16 v[112:127], v[204:207], a[8:11], v[112:127]
    ds_read_b64_tr_b16 v[212:213], v18 offset:6144
    ds_read_b64_tr_b16 v[214:215], v18 offset:7168
    v_mfma_f32_32x32x16_bf16 v[176:191], v[204:207], a[136:139], v[176:191]
    s_waitcnt vmcnt(13) lgkmcnt(2)
    v_mfma_f32_32x32x16_bf16 v[64:79], v[208:211], a[12:15], v[64:79]
    s_waitcnt vmcnt(12)
    ds_read_b64_tr_b16 v[216:217], v19 offset:6144
    ds_read_b64_tr_b16 v[218:219], v19 offset:7168
    buffer_load_dwordx4 a[32:35], v1, s[48:51], s70 offen offset:0 sc1
    s_xor_b32 s71, s98, 8192
    v_mfma_f32_32x32x16_bf16 v[128:143], v[208:211], a[140:143], v[128:143]
    s_waitcnt lgkmcnt(2)
    v_mfma_f32_32x32x16_bf16 v[80:95], v[212:215], a[12:15], v[80:95]
    ds_read_b64_tr_b16 v[220:221], v20 offset:6144
    ds_read_b64_tr_b16 v[222:223], v20 offset:7168
    buffer_load_dwordx4 a[160:163], v1, s[48:51], s71 offen offset:0 sc1
    v_mfma_f32_32x32x16_bf16 v[144:159], v[212:215], a[140:143], v[144:159]
    s_waitcnt lgkmcnt(2)
    v_mfma_f32_32x32x16_bf16 v[96:111], v[216:219], a[12:15], v[96:111]
    ds_read_b64_tr_b16 v[192:193], v17 offset:16384
    ds_read_b64_tr_b16 v[194:195], v17 offset:17408
    s_xor_b32 s91, s99, 4
    s_mul_i32 s91, s91, 229376
    s_add_u32 s91, s91, s22
    s_add_u32 m0, s13, 65536
    s_nop 0
    buffer_load_dwordx4 v6, s[36:39], s91 offen offset:0 lds
    v_mfma_f32_32x32x16_bf16 v[160:175], v[216:219], a[140:143], v[160:175]
    s_waitcnt lgkmcnt(2)
    v_mfma_f32_32x32x16_bf16 v[112:127], v[220:223], a[12:15], v[112:127]
    ds_read_b64_tr_b16 v[196:197], v18 offset:16384
    ds_read_b64_tr_b16 v[198:199], v18 offset:17408
    buffer_load_dwordx4 a[36:39], v1, s[48:51], s70 offen offset:1024 sc1
    v_mfma_f32_32x32x16_bf16 v[176:191], v[220:223], a[140:143], v[176:191]
    s_waitcnt vmcnt(14) lgkmcnt(2)
    buffer_load_dwordx4 a[164:167], v1, s[48:51], s71 offen offset:1024 sc1
    v_mfma_f32_32x32x16_bf16 v[64:79], v[192:195], a[16:19], v[64:79]
    s_waitcnt vmcnt(14)
    ds_read_b64_tr_b16 v[200:201], v19 offset:16384
    ds_read_b64_tr_b16 v[202:203], v19 offset:17408
    v_mfma_f32_32x32x16_bf16 v[128:143], v[192:195], a[144:147], v[128:143]
    s_waitcnt lgkmcnt(2)
    buffer_load_dwordx4 a[40:43], v1, s[48:51], s70 offen offset:2048 sc1
    v_mfma_f32_32x32x16_bf16 v[80:95], v[196:199], a[16:19], v[80:95]
    ds_read_b64_tr_b16 v[204:205], v20 offset:16384
    ds_read_b64_tr_b16 v[206:207], v20 offset:17408
    buffer_load_dwordx4 v7, s[36:39], s91 offen offset:1024 lds
    v_mfma_f32_32x32x16_bf16 v[144:159], v[196:199], a[144:147], v[144:159]
    s_waitcnt lgkmcnt(2)
    v_mfma_f32_32x32x16_bf16 v[96:111], v[200:203], a[16:19], v[96:111]
    ds_read_b64_tr_b16 v[208:209], v17 offset:18432
    ds_read_b64_tr_b16 v[210:211], v17 offset:19456
    v_mfma_f32_32x32x16_bf16 v[160:175], v[200:203], a[144:147], v[160:175]
    s_waitcnt lgkmcnt(2)
    buffer_load_dwordx4 a[168:171], v1, s[48:51], s71 offen offset:2048 sc1
    v_mfma_f32_32x32x16_bf16 v[112:127], v[204:207], a[16:19], v[112:127]
    ds_read_b64_tr_b16 v[212:213], v18 offset:18432
    ds_read_b64_tr_b16 v[214:215], v18 offset:19456
    v_mfma_f32_32x32x16_bf16 v[176:191], v[204:207], a[144:147], v[176:191]
    s_waitcnt vmcnt(15) lgkmcnt(2)
    buffer_load_dwordx4 a[44:47], v1, s[48:51], s70 offen offset:3072 sc1
    v_mfma_f32_32x32x16_bf16 v[64:79], v[208:211], a[20:23], v[64:79]
    s_waitcnt vmcnt(15)
    ds_read_b64_tr_b16 v[216:217], v19 offset:18432
    ds_read_b64_tr_b16 v[218:219], v19 offset:19456
    v_mfma_f32_32x32x16_bf16 v[128:143], v[208:211], a[148:151], v[128:143]
    s_waitcnt lgkmcnt(2)
    buffer_load_dwordx4 v8, s[36:39], s91 offen offset:2048 lds
    v_mfma_f32_32x32x16_bf16 v[80:95], v[212:215], a[20:23], v[80:95]
    ds_read_b64_tr_b16 v[220:221], v20 offset:18432
    ds_read_b64_tr_b16 v[222:223], v20 offset:19456
    v_mfma_f32_32x32x16_bf16 v[144:159], v[212:215], a[148:151], v[144:159]
    s_waitcnt lgkmcnt(2)
    buffer_load_dwordx4 a[172:175], v1, s[48:51], s71 offen offset:3072 sc1
    s_xor_b32 s70, s97, 12288
    v_mfma_f32_32x32x16_bf16 v[96:111], v[216:219], a[20:23], v[96:111]
    ds_read_b64_tr_b16 v[192:193], v17 offset:20480
    ds_read_b64_tr_b16 v[194:195], v17 offset:21504
    v_mfma_f32_32x32x16_bf16 v[160:175], v[216:219], a[148:151], v[160:175]
    s_waitcnt lgkmcnt(2)
    buffer_load_dwordx4 a[48:51], v1, s[48:51], s70 offen offset:0 sc1
    s_xor_b32 s71, s98, 12288
    v_mfma_f32_32x32x16_bf16 v[112:127], v[220:223], a[20:23], v[112:127]
    ds_read_b64_tr_b16 v[196:197], v18 offset:20480
    ds_read_b64_tr_b16 v[198:199], v18 offset:21504
    buffer_load_dwordx4 a[176:179], v1, s[48:51], s71 offen offset:0 sc1
    v_mfma_f32_32x32x16_bf16 v[176:191], v[220:223], a[148:151], v[176:191]
    s_waitcnt vmcnt(18) lgkmcnt(2)
    v_mfma_f32_32x32x16_bf16 v[64:79], v[192:195], a[24:27], v[64:79]
    s_waitcnt vmcnt(16)
    ds_read_b64_tr_b16 v[200:201], v19 offset:20480
    ds_read_b64_tr_b16 v[202:203], v19 offset:21504
    buffer_load_dwordx4 v9, s[36:39], s91 offen offset:3072 lds
    v_mfma_f32_32x32x16_bf16 v[128:143], v[192:195], a[152:155], v[128:143]
    s_waitcnt lgkmcnt(2)
    v_mfma_f32_32x32x16_bf16 v[80:95], v[196:199], a[24:27], v[80:95]
    ds_read_b64_tr_b16 v[204:205], v20 offset:20480
    ds_read_b64_tr_b16 v[206:207], v20 offset:21504
    buffer_load_dwordx4 a[52:55], v1, s[48:51], s70 offen offset:1024 sc1
    v_mfma_f32_32x32x16_bf16 v[144:159], v[196:199], a[152:155], v[144:159]
    s_waitcnt lgkmcnt(2)
    v_mfma_f32_32x32x16_bf16 v[96:111], v[200:203], a[24:27], v[96:111]
    ds_read_b64_tr_b16 v[208:209], v17 offset:22528
    ds_read_b64_tr_b16 v[210:211], v17 offset:23552
    buffer_load_dwordx4 a[180:183], v1, s[48:51], s71 offen offset:1024 sc1
    s_lshl_b32 s61, s17, 12
    s_add_u32 s61, s61, 4063232
    v_mfma_f32_32x32x16_bf16 v[160:175], v[200:203], a[152:155], v[160:175]
    s_waitcnt lgkmcnt(2)
    v_mfma_f32_32x32x16_bf16 v[112:127], v[204:207], a[24:27], v[112:127]
    ds_read_b64_tr_b16 v[212:213], v18 offset:22528
    ds_read_b64_tr_b16 v[214:215], v18 offset:23552
    buffer_load_dwordx4 v[232:235], v1, s[48:51], s61 offen offset:0 sc1
    v_mfma_f32_32x32x16_bf16 v[176:191], v[204:207], a[152:155], v[176:191]
    s_waitcnt vmcnt(19) lgkmcnt(2)
    s_xor_b32 s91, s99, 5
    s_mul_i32 s91, s91, 229376
    s_add_u32 s91, s91, s22
    s_add_u32 m0, s13, 81920
    s_nop 0
    buffer_load_dwordx4 v6, s[36:39], s91 offen offset:0 lds
    v_mfma_f32_32x32x16_bf16 v[64:79], v[208:211], a[28:31], v[64:79]
    s_waitcnt vmcnt(19)
    ds_read_b64_tr_b16 v[216:217], v19 offset:22528
    ds_read_b64_tr_b16 v[218:219], v19 offset:23552
    v_mfma_f32_32x32x16_bf16 v[128:143], v[208:211], a[156:159], v[128:143]
    s_waitcnt lgkmcnt(2)
    v_mfma_f32_32x32x16_bf16 v[80:95], v[212:215], a[28:31], v[80:95]
    ds_read_b64_tr_b16 v[220:221], v20 offset:22528
    ds_read_b64_tr_b16 v[222:223], v20 offset:23552
    buffer_load_dwordx4 v[236:239], v1, s[48:51], s61 offen offset:1024 sc1
    v_mfma_f32_32x32x16_bf16 v[144:159], v[212:215], a[156:159], v[144:159]
    s_waitcnt lgkmcnt(2)
    v_mfma_f32_32x32x16_bf16 v[96:111], v[216:219], a[28:31], v[96:111]
    ds_read_b64_tr_b16 v[192:193], v17 offset:32768
    ds_read_b64_tr_b16 v[194:195], v17 offset:33792
    buffer_load_dwordx4 a[56:59], v1, s[48:51], s70 offen offset:2048 sc1
    v_mfma_f32_32x32x16_bf16 v[160:175], v[216:219], a[156:159], v[160:175]
    s_waitcnt lgkmcnt(2)
    buffer_load_dwordx4 a[184:187], v1, s[48:51], s71 offen offset:2048 sc1
    v_mfma_f32_32x32x16_bf16 v[112:127], v[220:223], a[28:31], v[112:127]
    ds_read_b64_tr_b16 v[196:197], v18 offset:32768
    ds_read_b64_tr_b16 v[198:199], v18 offset:33792
    buffer_load_dwordx4 v7, s[36:39], s91 offen offset:1024 lds
    v_mfma_f32_32x32x16_bf16 v[176:191], v[220:223], a[156:159], v[176:191]
    s_waitcnt vmcnt(21) lgkmcnt(2)
    v_mfma_f32_32x32x16_bf16 v[64:79], v[192:195], a[32:35], v[64:79]
    s_waitcnt vmcnt(20)
    ds_read_b64_tr_b16 v[200:201], v19 offset:32768
    ds_read_b64_tr_b16 v[202:203], v19 offset:33792
    v_mfma_f32_32x32x16_bf16 v[128:143], v[192:195], a[160:163], v[128:143]
    s_waitcnt lgkmcnt(2)
    buffer_load_dwordx4 a[60:63], v1, s[48:51], s70 offen offset:3072 sc1
    v_mfma_f32_32x32x16_bf16 v[80:95], v[196:199], a[32:35], v[80:95]
    ds_read_b64_tr_b16 v[204:205], v20 offset:32768
    ds_read_b64_tr_b16 v[206:207], v20 offset:33792
    v_mfma_f32_32x32x16_bf16 v[144:159], v[196:199], a[160:163], v[144:159]
    s_waitcnt lgkmcnt(2)
    buffer_load_dwordx4 a[188:191], v1, s[48:51], s71 offen offset:3072 sc1
    s_xor_b32 s70, s97, 16384
    v_mfma_f32_32x32x16_bf16 v[96:111], v[200:203], a[32:35], v[96:111]
    ds_read_b64_tr_b16 v[208:209], v17 offset:34816
    ds_read_b64_tr_b16 v[210:211], v17 offset:35840
    buffer_load_dwordx4 v8, s[36:39], s91 offen offset:2048 lds
    v_mfma_f32_32x32x16_bf16 v[160:175], v[200:203], a[160:163], v[160:175]
    s_waitcnt lgkmcnt(2)
    v_mfma_f32_32x32x16_bf16 v[112:127], v[204:207], a[32:35], v[112:127]
    ds_read_b64_tr_b16 v[212:213], v18 offset:34816
    ds_read_b64_tr_b16 v[214:215], v18 offset:35840
    v_mfma_f32_32x32x16_bf16 v[176:191], v[204:207], a[160:163], v[176:191]
    s_waitcnt vmcnt(21) lgkmcnt(2)
    buffer_load_dwordx4 a[64:67], v1, s[48:51], s70 offen offset:0 sc1
    v_mfma_f32_32x32x16_bf16 v[64:79], v[208:211], a[36:39], v[64:79]
    s_waitcnt vmcnt(21)
    ds_read_b64_tr_b16 v[216:217], v19 offset:34816
    ds_read_b64_tr_b16 v[218:219], v19 offset:35840
    v_mfma_f32_32x32x16_bf16 v[128:143], v[208:211], a[164:167], v[128:143]
    s_waitcnt lgkmcnt(2)
    buffer_load_dwordx4 a[68:71], v1, s[48:51], s70 offen offset:1024 sc1
    v_mfma_f32_32x32x16_bf16 v[80:95], v[212:215], a[36:39], v[80:95]
    ds_read_b64_tr_b16 v[220:221], v20 offset:34816
    ds_read_b64_tr_b16 v[222:223], v20 offset:35840
    v_mfma_f32_32x32x16_bf16 v[144:159], v[212:215], a[164:167], v[144:159]
    s_waitcnt lgkmcnt(2)
    buffer_load_dwordx4 v9, s[36:39], s91 offen offset:3072 lds
    v_mfma_f32_32x32x16_bf16 v[96:111], v[216:219], a[36:39], v[96:111]
    ds_read_b64_tr_b16 v[192:193], v17 offset:36864
    ds_read_b64_tr_b16 v[194:195], v17 offset:37888
    buffer_load_dwordx4 a[72:75], v1, s[48:51], s70 offen offset:2048 sc1
    v_mfma_f32_32x32x16_bf16 v[160:175], v[216:219], a[164:167], v[160:175]
    s_waitcnt lgkmcnt(2)
    v_mfma_f32_32x32x16_bf16 v[112:127], v[220:223], a[36:39], v[112:127]
    ds_read_b64_tr_b16 v[196:197], v18 offset:36864
    ds_read_b64_tr_b16 v[198:199], v18 offset:37888
    buffer_load_dwordx4 a[76:79], v1, s[48:51], s70 offen offset:3072 sc1
    s_xor_b32 s70, s97, 20480
    v_mfma_f32_32x32x16_bf16 v[176:191], v[220:223], a[164:167], v[176:191]
    s_waitcnt vmcnt(24) lgkmcnt(2)
    v_mfma_f32_32x32x16_bf16 v[64:79], v[192:195], a[40:43], v[64:79]
    s_waitcnt vmcnt(22)
    ds_read_b64_tr_b16 v[200:201], v19 offset:36864
    ds_read_b64_tr_b16 v[202:203], v19 offset:37888
    buffer_load_dwordx4 a[80:83], v1, s[48:51], s70 offen offset:0 sc1
    v_mfma_f32_32x32x16_bf16 v[128:143], v[192:195], a[168:171], v[128:143]
    s_waitcnt lgkmcnt(2)
    v_mfma_f32_32x32x16_bf16 v[80:95], v[196:199], a[40:43], v[80:95]
    ds_read_b64_tr_b16 v[204:205], v20 offset:36864
    ds_read_b64_tr_b16 v[206:207], v20 offset:37888
    s_xor_b32 s91, s99, 6
    s_mul_i32 s91, s91, 229376
    s_add_u32 s91, s91, s22
    s_add_u32 m0, s13, 98304
    s_nop 0
    buffer_load_dwordx4 v6, s[36:39], s91 offen offset:0 lds
    v_mfma_f32_32x32x16_bf16 v[144:159], v[196:199], a[168:171], v[144:159]
    s_waitcnt lgkmcnt(2)
    v_mfma_f32_32x32x16_bf16 v[96:111], v[200:203], a[40:43], v[96:111]
    ds_read_b64_tr_b16 v[208:209], v17 offset:38912
    ds_read_b64_tr_b16 v[210:211], v17 offset:39936
    buffer_load_dwordx4 a[84:87], v1, s[48:51], s70 offen offset:1024 sc1
    v_mfma_f32_32x32x16_bf16 v[160:175], v[200:203], a[168:171], v[160:175]
    s_waitcnt lgkmcnt(2)
    v_mfma_f32_32x32x16_bf16 v[112:127], v[204:207], a[40:43], v[112:127]
    ds_read_b64_tr_b16 v[212:213], v18 offset:38912
    ds_read_b64_tr_b16 v[214:215], v18 offset:39936
    buffer_load_dwordx4 a[88:91], v1, s[48:51], s70 offen offset:2048 sc1
    v_mfma_f32_32x32x16_bf16 v[176:191], v[204:207], a[168:171], v[176:191]
    s_waitcnt vmcnt(25) lgkmcnt(2)
    v_mfma_f32_32x32x16_bf16 v[64:79], v[208:211], a[44:47], v[64:79]
    s_waitcnt vmcnt(23)
    ds_read_b64_tr_b16 v[216:217], v19 offset:38912
    ds_read_b64_tr_b16 v[218:219], v19 offset:39936
    buffer_load_dwordx4 a[92:95], v1, s[48:51], s70 offen offset:3072 sc1
    s_xor_b32 s70, s97, 24576
    v_mfma_f32_32x32x16_bf16 v[128:143], v[208:211], a[172:175], v[128:143]
    s_waitcnt lgkmcnt(2)
    buffer_load_dwordx4 v7, s[36:39], s91 offen offset:1024 lds
    v_mfma_f32_32x32x16_bf16 v[80:95], v[212:215], a[44:47], v[80:95]
    ds_read_b64_tr_b16 v[220:221], v20 offset:38912
    ds_read_b64_tr_b16 v[222:223], v20 offset:39936
    v_mfma_f32_32x32x16_bf16 v[144:159], v[212:215], a[172:175], v[144:159]
    s_waitcnt lgkmcnt(2)
    buffer_load_dwordx4 a[96:99], v1, s[48:51], s70 offen offset:0 sc1
    v_mfma_f32_32x32x16_bf16 v[96:111], v[216:219], a[44:47], v[96:111]
    s_barrier
    ds_read_b64_tr_b16 v[192:193], v17 offset:49152
    ds_read_b64_tr_b16 v[194:195], v17 offset:50176
    v_mfma_f32_32x32x16_bf16 v[160:175], v[216:219], a[172:175], v[160:175]
    s_waitcnt lgkmcnt(2)
    buffer_load_dwordx4 a[100:103], v1, s[48:51], s70 offen offset:1024 sc1
    v_mfma_f32_32x32x16_bf16 v[112:127], v[220:223], a[44:47], v[112:127]
    ds_read_b64_tr_b16 v[196:197], v18 offset:49152
    ds_read_b64_tr_b16 v[198:199], v18 offset:50176
    v_mfma_f32_32x32x16_bf16 v[176:191], v[220:223], a[172:175], v[176:191]
    s_waitcnt vmcnt(26) lgkmcnt(2)
    buffer_load_dwordx4 a[104:107], v1, s[48:51], s70 offen offset:2048 sc1
    v_mfma_f32_32x32x16_bf16 v[64:79], v[192:195], a[48:51], v[64:79]
    s_waitcnt vmcnt(26)
    ds_read_b64_tr_b16 v[200:201], v19 offset:49152
    ds_read_b64_tr_b16 v[202:203], v19 offset:50176
    buffer_load_dwordx4 v8, s[36:39], s91 offen offset:2048 lds
    v_mfma_f32_16x16x32_bf16 v[224:227], v[228:231], v[192:195], v[224:227]
    v_mfma_f32_32x32x16_bf16 v[128:143], v[192:195], a[176:179], v[128:143]
    s_waitcnt lgkmcnt(2)
    v_mfma_f32_32x32x16_bf16 v[80:95], v[196:199], a[48:51], v[80:95]
    ds_read_b64_tr_b16 v[204:205], v20 offset:49152
    ds_read_b64_tr_b16 v[206:207], v20 offset:50176
    buffer_load_dwordx4 a[108:111], v1, s[48:51], s70 offen offset:3072 sc1
    s_xor_b32 s70, s97, 28672
    v_mfma_f32_32x32x16_bf16 v[144:159], v[196:199], a[176:179], v[144:159]
    s_waitcnt lgkmcnt(2)
    v_mfma_f32_32x32x16_bf16 v[96:111], v[200:203], a[48:51], v[96:111]
    ds_read_b64_tr_b16 v[208:209], v17 offset:51200
    ds_read_b64_tr_b16 v[210:211], v17 offset:52224
    buffer_load_dwordx4 a[112:115], v1, s[48:51], s70 offen offset:0 sc1
    v_mfma_f32_32x32x16_bf16 v[160:175], v[200:203], a[176:179], v[160:175]
    s_waitcnt lgkmcnt(2)
    v_mfma_f32_32x32x16_bf16 v[112:127], v[204:207], a[48:51], v[112:127]
    ds_read_b64_tr_b16 v[212:213], v18 offset:51200
    ds_read_b64_tr_b16 v[214:215], v18 offset:52224
    buffer_load_dwordx4 v9, s[36:39], s91 offen offset:3072 lds
    v_mfma_f32_32x32x16_bf16 v[176:191], v[204:207], a[176:179], v[176:191]
    s_waitcnt vmcnt(28) lgkmcnt(2)
    v_mfma_f32_32x32x16_bf16 v[64:79], v[208:211], a[52:55], v[64:79]
    s_waitcnt vmcnt(27)
    ds_read_b64_tr_b16 v[216:217], v19 offset:51200
    ds_read_b64_tr_b16 v[218:219], v19 offset:52224
    buffer_load_dwordx4 a[116:119], v1, s[48:51], s70 offen offset:1024 sc1
    v_mfma_f32_16x16x32_bf16 v[224:227], v[228:231], v[208:211], v[224:227]
    v_mfma_f32_32x32x16_bf16 v[128:143], v[208:211], a[180:183], v[128:143]
    s_waitcnt lgkmcnt(2)
    buffer_load_dwordx4 a[120:123], v1, s[48:51], s70 offen offset:2048 sc1
    v_mfma_f32_32x32x16_bf16 v[80:95], v[212:215], a[52:55], v[80:95]
    ds_read_b64_tr_b16 v[220:221], v20 offset:51200
    ds_read_b64_tr_b16 v[222:223], v20 offset:52224
    v_mfma_f32_32x32x16_bf16 v[144:159], v[212:215], a[180:183], v[144:159]
    s_waitcnt lgkmcnt(2)
    buffer_load_dwordx4 a[124:127], v1, s[48:51], s70 offen offset:3072 sc1
    s_xor_b32 s71, s98, 16384
    s_waitcnt vmcnt(27)
    v_add_f32 v232, v232, v233
    v_add_f32 v234, v234, v235
    v_mfma_f32_32x32x16_bf16 v[96:111], v[216:219], a[52:55], v[96:111]
    ds_read_b64_tr_b16 v[192:193], v17 offset:53248
    ds_read_b64_tr_b16 v[194:195], v17 offset:54272
    v_add_f32 v236, v236, v237
    v_add_f32 v238, v238, v239
    v_add_f32 v232, v232, v236
    v_add_f32 v234, v234, v238
    v_mfma_f32_32x32x16_bf16 v[160:175], v[216:219], a[180:183], v[160:175]
    s_waitcnt lgkmcnt(2)
    s_xor_b32 s91, s99, 7
    s_mul_i32 s91, s91, 229376
    s_add_u32 s91, s91, s22
    s_add_u32 m0, s13, 114688
    s_nop 0
    buffer_load_dwordx4 v6, s[36:39], s91 offen offset:0 lds
    v_mfma_f32_32x32x16_bf16 v[112:127], v[220:223], a[52:55], v[112:127]
    ds_read_b64_tr_b16 v[196:197], v18 offset:53248
    ds_read_b64_tr_b16 v[198:199], v18 offset:54272
    v_permlane16_swap_b32 v232, v234
    v_add_f32 v232, v232, v234
    v_mov_b32 v234, v232
    v_mfma_f32_32x32x16_bf16 v[176:191], v[220:223], a[180:183], v[176:191]
    s_waitcnt vmcnt(27) lgkmcnt(2)
    buffer_load_dwordx4 a[192:195], v1, s[48:51], s71 offen offset:0 sc1
    v_permlane32_swap_b32 v232, v234
    v_add_f32 v232, v232, v234
    v_mul_f32 v250, s67, v232
    v_mfma_f32_32x32x16_bf16 v[64:79], v[192:195], a[56:59], v[64:79]
    s_waitcnt vmcnt(27)
    ds_read_b64_tr_b16 v[200:201], v19 offset:53248
    ds_read_b64_tr_b16 v[202:203], v19 offset:54272
    buffer_load_dwordx4 a[196:199], v1, s[48:51], s71 offen offset:1024 sc1
    v_and_b32 v251, s66, v250
    v_sub_f32 v250, v250, v251
    v_mfma_f32_16x16x32_bf16 v[224:227], v[228:231], v[192:195], v[224:227]
    s_nop 0
    v_permlane32_swap_b32 v251, v250
    v_mfma_f32_32x32x16_bf16 v[128:143], v[192:195], a[184:187], v[128:143]
    s_waitcnt lgkmcnt(2)
    s_lshl_b32 s61, s18, 12
    s_add_u32 s61, s61, 4063232
    buffer_load_dwordx4 v[232:235], v1, s[48:51], s61 offen offset:0 sc1
    buffer_load_dwordx4 v[236:239], v1, s[48:51], s61 offen offset:1024 sc1
    v_mfma_f32_32x32x16_bf16 v[80:95], v[196:199], a[56:59], v[80:95]
    ds_read_b64_tr_b16 v[204:205], v20 offset:53248
    ds_read_b64_tr_b16 v[206:207], v20 offset:54272
    v_cvt_pk_bf16_f32 v242, -v251, -v251
    v_mfma_f32_32x32x16_bf16 v[144:159], v[196:199], a[184:187], v[144:159]
    s_waitcnt lgkmcnt(2)
    v_mfma_f32_32x32x16_bf16 v[96:111], v[200:203], a[56:59], v[96:111]
    ds_read_b64_tr_b16 v[208:209], v17 offset:55296
    ds_read_b64_tr_b16 v[210:211], v17 offset:56320
    buffer_load_dwordx4 v7, s[36:39], s91 offen offset:1024 lds
    v_mfma_f32_32x32x16_bf16 v[160:175], v[200:203], a[184:187], v[160:175]
    s_waitcnt lgkmcnt(2)
    v_mfma_f32_32x32x16_bf16 v[112:127], v[204:207], a[56:59], v[112:127]
    ds_read_b64_tr_b16 v[212:213], v18 offset:55296
    ds_read_b64_tr_b16 v[214:215], v18 offset:56320
    v_mfma_f32_32x32x16_bf16 v[176:191], v[204:207], a[184:187], v[176:191]
    s_waitcnt vmcnt(29) lgkmcnt(2)
    buffer_load_dwordx4 a[200:203], v1, s[48:51], s71 offen offset:2048 sc1
    v_mfma_f32_32x32x16_bf16 v[64:79], v[208:211], a[60:63], v[64:79]
    s_waitcnt vmcnt(29)
    ds_read_b64_tr_b16 v[216:217], v19 offset:55296
    ds_read_b64_tr_b16 v[218:219], v19 offset:56320
    buffer_load_dwordx4 a[204:207], v1, s[48:51], s71 offen offset:3072 sc1
    s_xor_b32 s71, s98, 20480
    v_mfma_f32_16x16x32_bf16 v[224:227], v[228:231], v[208:211], v[224:227]
    v_mfma_f32_32x32x16_bf16 v[128:143], v[208:211], a[188:191], v[128:143]
    s_waitcnt lgkmcnt(2)
    v_mfma_f32_32x32x16_bf16 v[80:95], v[212:215], a[60:63], v[80:95]
    ds_read_b64_tr_b16 v[220:221], v20 offset:55296
    ds_read_b64_tr_b16 v[222:223], v20 offset:56320
    buffer_load_dwordx4 a[208:211], v1, s[48:51], s71 offen offset:0 sc1
    v_mfma_f32_32x32x16_bf16 v[144:159], v[212:215], a[188:191], v[144:159]
    s_waitcnt lgkmcnt(2)
    buffer_load_dwordx4 v8, s[36:39], s91 offen offset:2048 lds
    v_mfma_f32_32x32x16_bf16 v[96:111], v[216:219], a[60:63], v[96:111]
    s_barrier
    ds_read_b64_tr_b16 v[192:193], v21 offset:0
    ds_read_b64_tr_b16 v[194:195], v21 offset:1024
    v_mfma_f32_32x32x16_bf16 v[160:175], v[216:219], a[188:191], v[160:175]
    s_waitcnt lgkmcnt(2)
    ds_read_b64_tr_b16 v[196:197], v22 offset:0
    ds_read_b64_tr_b16 v[198:199], v22 offset:1024
    v_mfma_f32_32x32x16_bf16 v[112:127], v[220:223], a[60:63], v[112:127]
    ds_read_b64_tr_b16 v[200:201], v23 offset:0
    ds_read_b64_tr_b16 v[202:203], v23 offset:1024
    buffer_load_dwordx4 a[212:215], v1, s[48:51], s71 offen offset:1024 sc1
    v_mfma_f32_32x32x16_bf16 v[176:191], v[220:223], a[188:191], v[176:191]
    s_waitcnt vmcnt(31) lgkmcnt(4)
    ds_read_b64_tr_b16 v[204:205], v24 offset:0
    ds_read_b64_tr_b16 v[206:207], v24 offset:1024
    v_mfma_f32_32x32x16_bf16 v[64:79], v[192:195], a[64:67], v[64:79]
    s_waitcnt lgkmcnt(4)
    s_barrier
    ds_read_b64_tr_b16 v[208:209], v21 offset:2048
    ds_read_b64_tr_b16 v[210:211], v21 offset:3072
    buffer_load_dwordx4 a[216:219], v1, s[48:51], s71 offen offset:2048 sc1
    v_mfma_f32_16x16x32_bf16 v[224:227], v[228:231], v[192:195], v[224:227]
    v_mfma_f32_32x32x16_bf16 v[80:95], v[196:199], a[64:67], v[80:95]
    s_waitcnt lgkmcnt(4)
    ds_read_b64_tr_b16 v[212:213], v22 offset:2048
    ds_read_b64_tr_b16 v[214:215], v22 offset:3072
    buffer_load_dwordx4 a[220:223], v1, s[48:51], s71 offen offset:3072 sc1
    s_xor_b32 s71, s98, 24576
    v_mfma_f32_32x32x16_bf16 v[96:111], v[200:203], a[64:67], v[96:111]
    s_waitcnt lgkmcnt(4)
    ds_read_b64_tr_b16 v[216:217], v23 offset:2048
    ds_read_b64_tr_b16 v[218:219], v23 offset:3072
    buffer_load_dwordx4 v9, s[36:39], s91 offen offset:3072 lds
    v_mfma_f32_32x32x16_bf16 v[112:127], v[204:207], a[64:67], v[112:127]
    s_waitcnt vmcnt(33) lgkmcnt(4)
    ds_read_b64_tr_b16 v[220:221], v24 offset:2048
    ds_read_b64_tr_b16 v[222:223], v24 offset:3072
    v_mfma_f32_32x32x16_bf16 v[64:79], v[208:211], a[68:71], v[64:79]
    s_waitcnt lgkmcnt(4)
    ds_read_b64_tr_b16 v[192:193], v21 offset:4096
    ds_read_b64_tr_b16 v[194:195], v21 offset:5120
    v_mfma_f32_16x16x32_bf16 v[224:227], v[228:231], v[208:211], v[224:227]
    v_mfma_f32_32x32x16_bf16 v[80:95], v[212:215], a[68:71], v[80:95]
    s_waitcnt lgkmcnt(4)
    ds_read_b64_tr_b16 v[196:197], v22 offset:4096
    ds_read_b64_tr_b16 v[198:199], v22 offset:5120
    buffer_load_dwordx4 a[224:227], v1, s[48:51], s71 offen offset:0 sc1
    v_mfma_f32_32x32x16_bf16 v[96:111], v[216:219], a[68:71], v[96:111]
    s_waitcnt lgkmcnt(4)
    ds_read_b64_tr_b16 v[200:201], v23 offset:4096
    ds_read_b64_tr_b16 v[202:203], v23 offset:5120
    v_mfma_f32_32x32x16_bf16 v[112:127], v[220:223], a[68:71], v[112:127]
    s_waitcnt vmcnt(32) lgkmcnt(4)
    ds_read_b64_tr_b16 v[204:205], v24 offset:4096
    ds_read_b64_tr_b16 v[206:207], v24 offset:5120
    buffer_load_dwordx4 a[228:231], v1, s[48:51], s71 offen offset:1024 sc1
    v_mfma_f32_32x32x16_bf16 v[64:79], v[192:195], a[72:75], v[64:79]
    s_waitcnt lgkmcnt(4)
    ds_read_b64_tr_b16 v[208:209], v21 offset:6144
    ds_read_b64_tr_b16 v[210:211], v21 offset:7168
    buffer_load_dwordx4 a[232:235], v1, s[48:51], s71 offen offset:2048 sc1
    v_mfma_f32_16x16x32_bf16 v[224:227], v[228:231], v[192:195], v[224:227]
    v_mfma_f32_32x32x16_bf16 v[80:95], v[196:199], a[72:75], v[80:95]
    s_waitcnt lgkmcnt(4)
    ds_read_b64_tr_b16 v[212:213], v22 offset:6144
    ds_read_b64_tr_b16 v[214:215], v22 offset:7168
    s_waitcnt vmcnt(12)
    v_add_f32 v232, v232, v233
    v_add_f32 v234, v234, v235
    v_add_f32 v236, v236, v237
    v_mfma_f32_32x32x16_bf16 v[96:111], v[200:203], a[72:75], v[96:111]
    s_waitcnt lgkmcnt(4)
    ds_read_b64_tr_b16 v[216:217], v23 offset:6144
    ds_read_b64_tr_b16 v[218:219], v23 offset:7168
    buffer_load_dwordx4 a[236:239], v1, s[48:51], s71 offen offset:3072 sc1
    s_xor_b32 s71, s98, 28672
    v_add_f32 v238, v238, v239
    v_mfma_f32_32x32x16_bf16 v[112:127], v[204:207], a[72:75], v[112:127]
    s_waitcnt lgkmcnt(4)
    ds_read_b64_tr_b16 v[220:221], v24 offset:6144
    ds_read_b64_tr_b16 v[222:223], v24 offset:7168
    v_add_f32 v232, v232, v236
    v_add_f32 v234, v234, v238
    s_nop 1
    v_permlane16_swap_b32 v232, v234
    v_mfma_f32_32x32x16_bf16 v[64:79], v[208:211], a[76:79], v[64:79]
    s_waitcnt lgkmcnt(4)
    s_barrier
    ds_read_b64_tr_b16 v[192:193], v21 offset:16384
    ds_read_b64_tr_b16 v[194:195], v21 offset:17408
    buffer_load_dwordx4 a[240:243], v1, s[48:51], s71 offen offset:0 sc1
    v_add_f32 v232, v232, v234
    v_mfma_f32_16x16x32_bf16 v[224:227], v[228:231], v[208:211], v[224:227]
    v_mov_b32 v234, v232
    s_nop 1
    v_permlane32_swap_b32 v232, v234
    v_mfma_f32_32x32x16_bf16 v[80:95], v[212:215], a[76:79], v[80:95]
    s_waitcnt lgkmcnt(4)
    ds_read_b64_tr_b16 v[196:197], v22 offset:16384
    ds_read_b64_tr_b16 v[198:199], v22 offset:17408
    buffer_load_dwordx4 a[244:247], v1, s[48:51], s71 offen offset:1024 sc1
    v_add_f32 v232, v232, v234
    v_mul_f32 v250, s67, v232
    v_mfma_f32_32x32x16_bf16 v[96:111], v[216:219], a[76:79], v[96:111]
    s_waitcnt lgkmcnt(4)
    ds_read_b64_tr_b16 v[200:201], v23 offset:16384
    ds_read_b64_tr_b16 v[202:203], v23 offset:17408
    v_and_b32 v251, s66, v250
    v_sub_f32 v250, v250, v251
    s_nop 1
    v_permlane32_swap_b32 v251, v250
    v_mfma_f32_32x32x16_bf16 v[112:127], v[220:223], a[76:79], v[112:127]
    s_waitcnt lgkmcnt(4)
    ds_read_b64_tr_b16 v[204:205], v24 offset:16384
    ds_read_b64_tr_b16 v[206:207], v24 offset:17408
    buffer_load_dwordx4 a[248:251], v1, s[48:51], s71 offen offset:2048 sc1
    s_add_u32 s62, s23, 0
    v_cvt_pk_bf16_f32 v246, -v251, -v251
    v_mfma_f32_32x32x16_bf16 v[64:79], v[192:195], a[80:83], v[64:79]
    s_waitcnt lgkmcnt(4)
    ds_read_b64_tr_b16 v[208:209], v21 offset:18432
    ds_read_b64_tr_b16 v[210:211], v21 offset:19456
    s_add_u32 m0, s13, 131072
    s_nop 0
    buffer_load_dwordx4 v10, s[40:43], s62 offen offset:0 lds
    v_mov_b32 v233, 0
    v_mfma_f32_16x16x32_bf16 v[224:227], v[228:231], v[192:195], v[224:227]
    v_mov_b32 v235, 0
    v_mov_b32 v237, 0
    v_mfma_f32_32x32x16_bf16 v[80:95], v[196:199], a[80:83], v[80:95]
    s_waitcnt lgkmcnt(4)
    ds_read_b64_tr_b16 v[212:213], v22 offset:18432
    ds_read_b64_tr_b16 v[214:215], v22 offset:19456
    v_mov_b32 v239, 0
    v_mfma_f32_32x32x16_bf16 v[96:111], v[200:203], a[80:83], v[96:111]
    s_waitcnt lgkmcnt(4)
    ds_read_b64_tr_b16 v[216:217], v23 offset:18432
    ds_read_b64_tr_b16 v[218:219], v23 offset:19456
    buffer_load_dwordx4 v11, s[40:43], s62 offen offset:1024 lds
    v_mfma_f32_32x32x16_bf16 v[112:127], v[204:207], a[80:83], v[112:127]
    s_waitcnt lgkmcnt(4)
    ds_read_b64_tr_b16 v[220:221], v24 offset:18432
    ds_read_b64_tr_b16 v[222:223], v24 offset:19456
    v_mfma_f32_32x32x16_bf16 v[64:79], v[208:211], a[84:87], v[64:79]
    s_waitcnt lgkmcnt(4)
    ds_read_b64_tr_b16 v[192:193], v21 offset:20480
    ds_read_b64_tr_b16 v[194:195], v21 offset:21504
    buffer_load_dwordx4 v12, s[40:43], s62 offen offset:2048 lds
    v_mfma_f32_16x16x32_bf16 v[224:227], v[228:231], v[208:211], v[224:227]
    v_mfma_f32_32x32x16_bf16 v[80:95], v[212:215], a[84:87], v[80:95]
    s_waitcnt lgkmcnt(4)
    ds_read_b64_tr_b16 v[196:197], v22 offset:20480
    ds_read_b64_tr_b16 v[198:199], v22 offset:21504
    buffer_load_dwordx4 v13, s[40:43], s62 offen offset:3072 lds
    v_mfma_f32_32x32x16_bf16 v[96:111], v[216:219], a[84:87], v[96:111]
    s_waitcnt lgkmcnt(4)
    ds_read_b64_tr_b16 v[200:201], v23 offset:20480
    ds_read_b64_tr_b16 v[202:203], v23 offset:21504
    v_mfma_f32_32x32x16_bf16 v[112:127], v[220:223], a[84:87], v[112:127]
    s_waitcnt lgkmcnt(4)
    ds_read_b64_tr_b16 v[204:205], v24 offset:20480
    ds_read_b64_tr_b16 v[206:207], v24 offset:21504
    buffer_load_dwordx4 a[252:255], v1, s[48:51], s71 offen offset:3072 sc1
    s_add_u32 s62, s23, 131072
    v_mfma_f32_32x32x16_bf16 v[64:79], v[192:195], a[88:91], v[64:79]
    s_waitcnt lgkmcnt(4)
    ds_read_b64_tr_b16 v[208:209], v21 offset:22528
    ds_read_b64_tr_b16 v[210:211], v21 offset:23552
    v_mfma_f32_16x16x32_bf16 v[224:227], v[228:231], v[192:195], v[224:227]
    v_mfma_f32_32x32x16_bf16 v[80:95], v[196:199], a[88:91], v[80:95]
    s_waitcnt lgkmcnt(4)
    ds_read_b64_tr_b16 v[212:213], v22 offset:22528
    ds_read_b64_tr_b16 v[214:215], v22 offset:23552
    s_add_u32 m0, s13, 0
    s_nop 0
    buffer_load_dwordx4 v10, s[40:43], s62 offen offset:0 lds
    v_mfma_f32_32x32x16_bf16 v[96:111], v[200:203], a[88:91], v[96:111]
    s_waitcnt lgkmcnt(4)
    ds_read_b64_tr_b16 v[216:217], v23 offset:22528
    ds_read_b64_tr_b16 v[218:219], v23 offset:23552
    v_mfma_f32_32x32x16_bf16 v[112:127], v[204:207], a[88:91], v[112:127]
    s_waitcnt lgkmcnt(4)
    ds_read_b64_tr_b16 v[220:221], v24 offset:22528
    ds_read_b64_tr_b16 v[222:223], v24 offset:23552
    buffer_load_dwordx4 v11, s[40:43], s62 offen offset:1024 lds
    v_mfma_f32_32x32x16_bf16 v[64:79], v[208:211], a[92:95], v[64:79]
    s_waitcnt lgkmcnt(4)
    s_barrier
    ds_read_b64_tr_b16 v[192:193], v21 offset:32768
    ds_read_b64_tr_b16 v[194:195], v21 offset:33792
    buffer_load_dwordx4 v12, s[40:43], s62 offen offset:2048 lds
    v_mfma_f32_16x16x32_bf16 v[224:227], v[228:231], v[208:211], v[224:227]
    v_mfma_f32_32x32x16_bf16 v[80:95], v[212:215], a[92:95], v[80:95]
    s_waitcnt lgkmcnt(4)
    ds_read_b64_tr_b16 v[196:197], v21 offset:34816
    ds_read_b64_tr_b16 v[198:199], v21 offset:35840
    v_mfma_f32_32x32x16_bf16 v[96:111], v[216:219], a[92:95], v[96:111]
    s_waitcnt lgkmcnt(4)
    ds_read_b64_tr_b16 v[200:201], v21 offset:36864
    ds_read_b64_tr_b16 v[202:203], v21 offset:37888
    buffer_load_dwordx4 v13, s[40:43], s62 offen offset:3072 lds
    s_add_u32 s62, s23, 262144
    v_mfma_f32_32x32x16_bf16 v[112:127], v[220:223], a[92:95], v[112:127]
    s_waitcnt lgkmcnt(4)
    ds_read_b64_tr_b16 v[204:205], v21 offset:38912
    ds_read_b64_tr_b16 v[206:207], v21 offset:39936
    v_mfma_f32_32x32x16_bf16 v[64:79], v[192:195], a[96:99], v[64:79]
    s_waitcnt lgkmcnt(4)
    s_waitcnt vmcnt(16)
    s_barrier
    ds_read_b64_tr_b16 v[208:209], v21 offset:49152
    ds_read_b64_tr_b16 v[210:211], v21 offset:50176
    s_add_u32 m0, s13, 16384
    s_nop 0
    buffer_load_dwordx4 v10, s[40:43], s62 offen offset:0 lds
    v_mfma_f32_16x16x32_bf16 v[224:227], v[228:231], v[192:195], v[224:227]
    v_mfma_f32_32x32x16_bf16 v[64:79], v[196:199], a[100:103], v[64:79]
    s_waitcnt lgkmcnt(4)
    ds_read_b64_tr_b16 v[212:213], v21 offset:51200
    ds_read_b64_tr_b16 v[214:215], v21 offset:52224
    buffer_load_dwordx4 v11, s[40:43], s62 offen offset:1024 lds
    v_mfma_f32_16x16x32_bf16 v[224:227], v[228:231], v[196:199], v[224:227]
    v_mfma_f32_32x32x16_bf16 v[64:79], v[200:203], a[104:107], v[64:79]
    s_waitcnt lgkmcnt(4)
    ds_read_b64_tr_b16 v[216:217], v21 offset:53248
    ds_read_b64_tr_b16 v[218:219], v21 offset:54272
    buffer_load_dwordx4 v12, s[40:43], s62 offen offset:2048 lds
    v_mfma_f32_16x16x32_bf16 v[224:227], v[228:231], v[200:203], v[224:227]
    v_mfma_f32_32x32x16_bf16 v[64:79], v[204:207], a[108:111], v[64:79]
    s_waitcnt lgkmcnt(4)
    ds_read_b64_tr_b16 v[220:221], v21 offset:55296
    ds_read_b64_tr_b16 v[222:223], v21 offset:56320
    buffer_load_dwordx4 v13, s[40:43], s62 offen offset:3072 lds
    s_add_u32 s62, s23, 393216
    v_mfma_f32_16x16x32_bf16 v[224:227], v[228:231], v[204:207], v[224:227]
    v_mfma_f32_32x32x16_bf16 v[64:79], v[208:211], a[112:115], v[64:79]
    s_waitcnt lgkmcnt(4)
    ds_read_b64_tr_b16 v[192:193], v22 offset:32768
    ds_read_b64_tr_b16 v[194:195], v22 offset:33792
    v_mfma_f32_16x16x32_bf16 v[224:227], v[228:231], v[208:211], v[224:227]
    v_mfma_f32_32x32x16_bf16 v[64:79], v[212:215], a[116:119], v[64:79]
    s_waitcnt lgkmcnt(4)
    ds_read_b64_tr_b16 v[196:197], v22 offset:34816
    ds_read_b64_tr_b16 v[198:199], v22 offset:35840
    s_add_u32 m0, s13, 32768
    s_nop 0
    buffer_load_dwordx4 v10, s[40:43], s62 offen offset:0 lds
    v_mfma_f32_16x16x32_bf16 v[224:227], v[228:231], v[212:215], v[224:227]
    v_mfma_f32_32x32x16_bf16 v[64:79], v[216:219], a[120:123], v[64:79]
    s_waitcnt lgkmcnt(4)
    ds_read_b64_tr_b16 v[200:201], v22 offset:36864
    ds_read_b64_tr_b16 v[202:203], v22 offset:37888
    buffer_load_dwordx4 v11, s[40:43], s62 offen offset:1024 lds
    v_mfma_f32_16x16x32_bf16 v[224:227], v[228:231], v[216:219], v[224:227]
    v_mfma_f32_32x32x16_bf16 v[64:79], v[220:223], a[124:127], v[64:79]
    s_waitcnt lgkmcnt(4)
    ds_read_b64_tr_b16 v[204:205], v22 offset:38912
    ds_read_b64_tr_b16 v[206:207], v22 offset:39936
    buffer_load_dwordx4 v12, s[40:43], s62 offen offset:2048 lds
    v_mfma_f32_16x16x32_bf16 v[224:227], v[228:231], v[220:223], v[224:227]
    v_mfma_f32_32x32x16_bf16 v[80:95], v[192:195], a[96:99], v[80:95]
    s_waitcnt lgkmcnt(4)
    ds_read_b64_tr_b16 v[208:209], v22 offset:49152
    ds_read_b64_tr_b16 v[210:211], v22 offset:50176
    v_mfma_f32_32x32x16_bf16 v[80:95], v[196:199], a[100:103], v[80:95]
    s_waitcnt lgkmcnt(4)
    ds_read_b64_tr_b16 v[212:213], v22 offset:51200
    ds_read_b64_tr_b16 v[214:215], v22 offset:52224
    buffer_load_dwordx4 v13, s[40:43], s62 offen offset:3072 lds
    s_add_u32 s62, s23, 524288
    v_and_b32 v225, s66, v224
    v_mfma_f32_32x32x16_bf16 v[80:95], v[200:203], a[104:107], v[80:95]
    s_waitcnt lgkmcnt(4)
    ds_read_b64_tr_b16 v[216:217], v22 offset:53248
    ds_read_b64_tr_b16 v[218:219], v22 offset:54272
    v_sub_f32 v224, v224, v225
    v_cvt_pk_bf16_f32 v224, v225, v224
    ds_write_b32 v59, v224
    v_xor_b32 v225, 128, v59
    v_mfma_f32_32x32x16_bf16 v[80:95], v[204:207], a[108:111], v[80:95]
    s_waitcnt lgkmcnt(5)
    ds_read_b64_tr_b16 v[220:221], v22 offset:55296
    ds_read_b64_tr_b16 v[222:223], v22 offset:56320
    s_add_u32 m0, s13, 49152
    s_nop 0
    buffer_load_dwordx4 v10, s[40:43], s62 offen offset:0 lds
    v_xor_b32 v226, 256, v59
    v_mfma_f32_32x32x16_bf16 v[80:95], v[208:211], a[112:115], v[80:95]
    s_waitcnt lgkmcnt(5)
    ds_read_b64_tr_b16 v[192:193], v23 offset:32768
    ds_read_b64_tr_b16 v[194:195], v23 offset:33792
    v_xor_b32 v227, 384, v59
    v_mfma_f32_32x32x16_bf16 v[80:95], v[212:215], a[116:119], v[80:95]
    s_waitcnt lgkmcnt(5)
    s_waitcnt lgkmcnt(4)
    s_barrier
    ds_read_b32 v232, v59
    ds_read_b32 v234, v225
    ds_read_b32 v236, v226
    ds_read_b32 v238, v227
    ds_read_b64_tr_b16 v[196:197], v23 offset:34816
    ds_read_b64_tr_b16 v[198:199], v23 offset:35840
    v_mfma_f32_32x32x16_bf16 v[80:95], v[216:219], a[120:123], v[80:95]
    s_waitcnt lgkmcnt(8)
    ds_read_b64_tr_b16 v[200:201], v23 offset:36864
    ds_read_b64_tr_b16 v[202:203], v23 offset:37888
    buffer_load_dwordx4 v11, s[40:43], s62 offen offset:1024 lds
    buffer_load_dwordx4 v12, s[40:43], s62 offen offset:2048 lds
    v_mfma_f32_32x32x16_bf16 v[80:95], v[220:223], a[124:127], v[80:95]
    s_waitcnt lgkmcnt(8)
    ds_read_b64_tr_b16 v[204:205], v23 offset:38912
    ds_read_b64_tr_b16 v[206:207], v23 offset:39936
    v_mfma_f32_32x32x16_bf16 v[96:111], v[192:195], a[96:99], v[96:111]
    s_waitcnt lgkmcnt(4)
    ds_read_b64_tr_b16 v[208:209], v23 offset:49152
    ds_read_b64_tr_b16 v[210:211], v23 offset:50176
    buffer_load_dwordx4 v13, s[40:43], s62 offen offset:3072 lds
    v_mfma_f32_32x32x16_bf16 v[96:111], v[196:199], a[100:103], v[96:111]
    s_waitcnt lgkmcnt(4)
    ds_read_b64_tr_b16 v[212:213], v23 offset:51200
    ds_read_b64_tr_b16 v[214:215], v23 offset:52224
    v_mfma_f32_32x32x16_bf16 v[64:79], v[232:235], v[242:245], v[64:79]
    v_mfma_f32_32x32x16_bf16 v[80:95], v[234:237], v[242:245], v[80:95]
    v_mfma_f32_32x32x16_bf16 v[96:111], v[236:239], v[242:245], v[96:111]
    v_mfma_f32_32x32x16_bf16 v[112:127], v[238:241], v[242:245], v[112:127]
    v_mfma_f32_32x32x16_bf16 v[96:111], v[200:203], a[104:107], v[96:111]
    s_waitcnt lgkmcnt(4)
    ds_read_b64_tr_b16 v[216:217], v23 offset:53248
    ds_read_b64_tr_b16 v[218:219], v23 offset:54272
    v_mfma_f32_32x32x16_bf16 v[96:111], v[204:207], a[108:111], v[96:111]
    s_waitcnt lgkmcnt(4)
    ds_read_b64_tr_b16 v[220:221], v23 offset:55296
    ds_read_b64_tr_b16 v[222:223], v23 offset:56320
    s_xor_b32 s86, s87, 0
    v_mul_f32 v64, v64, v72
    v_mul_f32 v65, v65, v73
    v_mul_f32 v66, v66, v74
    v_mfma_f32_32x32x16_bf16 v[96:111], v[208:211], a[112:115], v[96:111]
    s_waitcnt lgkmcnt(4)
    ds_read_b64_tr_b16 v[192:193], v24 offset:32768
    ds_read_b64_tr_b16 v[194:195], v24 offset:33792
    v_mul_f32 v67, v67, v75
    v_mul_f32 v68, v68, v76
    v_mul_f32 v69, v69, v77
    v_mul_f32 v70, v70, v78
    v_mfma_f32_32x32x16_bf16 v[96:111], v[212:215], a[116:119], v[96:111]
    s_waitcnt lgkmcnt(4)
    ds_read_b64_tr_b16 v[196:197], v24 offset:34816
    ds_read_b64_tr_b16 v[198:199], v24 offset:35840
    v_mul_f32 v71, v71, v79
    v_cvt_pk_bf16_f32 v72, v64, v65
    v_cvt_pk_bf16_f32 v73, v66, v67
    v_cvt_pk_bf16_f32 v74, v68, v69
    v_mfma_f32_32x32x16_bf16 v[96:111], v[216:219], a[120:123], v[96:111]
    s_waitcnt lgkmcnt(4)
    ds_read_b64_tr_b16 v[200:201], v24 offset:36864
    ds_read_b64_tr_b16 v[202:203], v24 offset:37888
    v_cvt_pk_bf16_f32 v75, v70, v71
    buffer_store_dwordx4 v[72:75], v1, s[48:51], s86 offen sc1
    v_mfma_f32_32x32x16_bf16 v[96:111], v[220:223], a[124:127], v[96:111]
    s_waitcnt lgkmcnt(4)
    ds_read_b64_tr_b16 v[204:205], v24 offset:38912
    ds_read_b64_tr_b16 v[206:207], v24 offset:39936
    s_xor_b32 s86, s87, 1024
    v_mul_f32 v80, v80, v88
    v_mul_f32 v81, v81, v89
    v_mul_f32 v82, v82, v90
    v_mfma_f32_32x32x16_bf16 v[112:127], v[192:195], a[96:99], v[112:127]
    s_waitcnt lgkmcnt(4)
    ds_read_b64_tr_b16 v[208:209], v24 offset:49152
    ds_read_b64_tr_b16 v[210:211], v24 offset:50176
    v_mul_f32 v83, v83, v91
    v_mul_f32 v84, v84, v92
    v_mul_f32 v85, v85, v93
    v_mul_f32 v86, v86, v94
    v_mfma_f32_32x32x16_bf16 v[112:127], v[196:199], a[100:103], v[112:127]
    s_waitcnt lgkmcnt(4)
    ds_read_b64_tr_b16 v[212:213], v24 offset:51200
    ds_read_b64_tr_b16 v[214:215], v24 offset:52224
    v_mul_f32 v87, v87, v95
    v_cvt_pk_bf16_f32 v88, v80, v81
    v_cvt_pk_bf16_f32 v89, v82, v83
    v_cvt_pk_bf16_f32 v90, v84, v85
    v_mfma_f32_32x32x16_bf16 v[128:143], v[232:235], v[246:249], v[128:143]
    v_cvt_pk_bf16_f32 v91, v86, v87
    buffer_store_dwordx4 v[88:91], v1, s[48:51], s86 offen sc1
    v_mfma_f32_32x32x16_bf16 v[144:159], v[234:237], v[246:249], v[144:159]
    v_mfma_f32_32x32x16_bf16 v[160:175], v[236:239], v[246:249], v[160:175]
    v_mfma_f32_32x32x16_bf16 v[176:191], v[238:241], v[246:249], v[176:191]
    v_mfma_f32_32x32x16_bf16 v[112:127], v[200:203], a[104:107], v[112:127]
    s_waitcnt lgkmcnt(4)
    ds_read_b64_tr_b16 v[216:217], v24 offset:53248
    ds_read_b64_tr_b16 v[218:219], v24 offset:54272
    v_mfma_f32_32x32x16_bf16 v[112:127], v[204:207], a[108:111], v[112:127]
    s_waitcnt lgkmcnt(4)
    ds_read_b64_tr_b16 v[220:221], v24 offset:55296
    ds_read_b64_tr_b16 v[222:223], v24 offset:56320
    s_xor_b32 s86, s87, 2048
    v_mul_f32 v96, v96, v104
    v_mul_f32 v97, v97, v105
    v_mul_f32 v98, v98, v106
    v_mfma_f32_32x32x16_bf16 v[112:127], v[208:211], a[112:115], v[112:127]
    s_waitcnt lgkmcnt(4)
    ds_read_b64_tr_b16 v[192:193], v21 offset:0
    ds_read_b64_tr_b16 v[194:195], v21 offset:1024
    v_mul_f32 v99, v99, v107
    v_mul_f32 v100, v100, v108
    v_mul_f32 v101, v101, v109
    v_mul_f32 v102, v102, v110
    v_mfma_f32_32x32x16_bf16 v[112:127], v[212:215], a[116:119], v[112:127]
    s_waitcnt lgkmcnt(4)
    ds_read_b64_tr_b16 v[196:197], v22 offset:0
    ds_read_b64_tr_b16 v[198:199], v22 offset:1024
    v_mul_f32 v103, v103, v111
    v_cvt_pk_bf16_f32 v104, v96, v97
    v_cvt_pk_bf16_f32 v105, v98, v99
    v_cvt_pk_bf16_f32 v106, v100, v101
    v_mfma_f32_32x32x16_bf16 v[112:127], v[216:219], a[120:123], v[112:127]
    s_waitcnt lgkmcnt(4)
    ds_read_b64_tr_b16 v[200:201], v23 offset:0
    ds_read_b64_tr_b16 v[202:203], v23 offset:1024
    v_cvt_pk_bf16_f32 v107, v102, v103
    buffer_store_dwordx4 v[104:107], v1, s[48:51], s86 offen sc1
    v_mfma_f32_32x32x16_bf16 v[112:127], v[220:223], a[124:127], v[112:127]
    s_waitcnt lgkmcnt(4)
    ds_read_b64_tr_b16 v[204:205], v24 offset:0
    ds_read_b64_tr_b16 v[206:207], v24 offset:1024
    v_mfma_f32_32x32x16_bf16 v[128:143], v[192:195], a[192:195], v[128:143]
    s_waitcnt lgkmcnt(4)
    ds_read_b64_tr_b16 v[208:209], v21 offset:2048
    ds_read_b64_tr_b16 v[210:211], v21 offset:3072
    v_mfma_f32_32x32x16_bf16 v[144:159], v[196:199], a[192:195], v[144:159]
    s_waitcnt lgkmcnt(4)
    ds_read_b64_tr_b16 v[212:213], v22 offset:2048
    ds_read_b64_tr_b16 v[214:215], v22 offset:3072
    v_mfma_f32_32x32x16_bf16 v[160:175], v[200:203], a[192:195], v[160:175]
    s_waitcnt lgkmcnt(4)
    ds_read_b64_tr_b16 v[216:217], v23 offset:2048
    ds_read_b64_tr_b16 v[218:219], v23 offset:3072
    s_xor_b32 s86, s87, 3072
    v_mul_f32 v112, v112, v120
    v_mul_f32 v113, v113, v121
    v_mul_f32 v114, v114, v122
    v_mfma_f32_32x32x16_bf16 v[176:191], v[204:207], a[192:195], v[176:191]
    s_waitcnt lgkmcnt(4)
    ds_read_b64_tr_b16 v[220:221], v24 offset:2048
    ds_read_b64_tr_b16 v[222:223], v24 offset:3072
    v_mul_f32 v115, v115, v123
    v_mul_f32 v116, v116, v124
    v_mul_f32 v117, v117, v125
    v_mul_f32 v118, v118, v126
    v_mfma_f32_32x32x16_bf16 v[128:143], v[208:211], a[196:199], v[128:143]
    s_waitcnt lgkmcnt(4)
    ds_read_b64_tr_b16 v[192:193], v21 offset:4096
    ds_read_b64_tr_b16 v[194:195], v21 offset:5120
    v_mul_f32 v119, v119, v127
    v_cvt_pk_bf16_f32 v120, v112, v113
    v_cvt_pk_bf16_f32 v121, v114, v115
    v_cvt_pk_bf16_f32 v122, v116, v117
    v_mfma_f32_32x32x16_bf16 v[144:159], v[212:215], a[196:199], v[144:159]
    s_waitcnt lgkmcnt(4)
    ds_read_b64_tr_b16 v[196:197], v22 offset:4096
    ds_read_b64_tr_b16 v[198:199], v22 offset:5120
    v_cvt_pk_bf16_f32 v123, v118, v119
    buffer_store_dwordx4 v[120:123], v1, s[48:51], s86 offen sc1
    v_mfma_f32_32x32x16_bf16 v[160:175], v[216:219], a[196:199], v[160:175]
    s_waitcnt lgkmcnt(4)
    ds_read_b64_tr_b16 v[200:201], v23 offset:4096
    ds_read_b64_tr_b16 v[202:203], v23 offset:5120
    v_mfma_f32_32x32x16_bf16 v[176:191], v[220:223], a[196:199], v[176:191]
    s_waitcnt lgkmcnt(4)
    ds_read_b64_tr_b16 v[204:205], v24 offset:4096
    ds_read_b64_tr_b16 v[206:207], v24 offset:5120
    v_mfma_f32_32x32x16_bf16 v[128:143], v[192:195], a[200:203], v[128:143]
    s_waitcnt lgkmcnt(4)
    ds_read_b64_tr_b16 v[208:209], v21 offset:6144
    ds_read_b64_tr_b16 v[210:211], v21 offset:7168
    v_mfma_f32_32x32x16_bf16 v[144:159], v[196:199], a[200:203], v[144:159]
    s_waitcnt lgkmcnt(4)
    ds_read_b64_tr_b16 v[212:213], v22 offset:6144
    ds_read_b64_tr_b16 v[214:215], v22 offset:7168
    v_mfma_f32_32x32x16_bf16 v[160:175], v[200:203], a[200:203], v[160:175]
    s_waitcnt lgkmcnt(4)
    ds_read_b64_tr_b16 v[216:217], v23 offset:6144
    ds_read_b64_tr_b16 v[218:219], v23 offset:7168
    v_mfma_f32_32x32x16_bf16 v[176:191], v[204:207], a[200:203], v[176:191]
    s_waitcnt lgkmcnt(4)
    ds_read_b64_tr_b16 v[220:221], v24 offset:6144
    ds_read_b64_tr_b16 v[222:223], v24 offset:7168
    v_mfma_f32_32x32x16_bf16 v[128:143], v[208:211], a[204:207], v[128:143]
    s_waitcnt lgkmcnt(4)
    ds_read_b64_tr_b16 v[192:193], v21 offset:16384
    ds_read_b64_tr_b16 v[194:195], v21 offset:17408
    v_mfma_f32_32x32x16_bf16 v[144:159], v[212:215], a[204:207], v[144:159]
    s_waitcnt lgkmcnt(4)
    ds_read_b64_tr_b16 v[196:197], v22 offset:16384
    ds_read_b64_tr_b16 v[198:199], v22 offset:17408
    v_mfma_f32_32x32x16_bf16 v[160:175], v[216:219], a[204:207], v[160:175]
    s_waitcnt lgkmcnt(4)
    ds_read_b64_tr_b16 v[200:201], v23 offset:16384
    ds_read_b64_tr_b16 v[202:203], v23 offset:17408
    v_mfma_f32_32x32x16_bf16 v[176:191], v[220:223], a[204:207], v[176:191]
    s_waitcnt lgkmcnt(4)
    ds_read_b64_tr_b16 v[204:205], v24 offset:16384
    ds_read_b64_tr_b16 v[206:207], v24 offset:17408
    v_mfma_f32_32x32x16_bf16 v[128:143], v[192:195], a[208:211], v[128:143]
    s_waitcnt lgkmcnt(4)
    s_barrier
    ds_read_b64_tr_b16 v[208:209], v21 offset:18432
    ds_read_b64_tr_b16 v[210:211], v21 offset:19456
    s_add_u32 s62, s23, 655360
    s_add_u32 m0, s13, 65536
    s_nop 0
    buffer_load_dwordx4 v10, s[40:43], s62 offen offset:0 lds
    v_mfma_f32_32x32x16_bf16 v[144:159], v[196:199], a[208:211], v[144:159]
    s_waitcnt lgkmcnt(4)
    ds_read_b64_tr_b16 v[212:213], v22 offset:18432
    ds_read_b64_tr_b16 v[214:215], v22 offset:19456
    buffer_load_dwordx4 v11, s[40:43], s62 offen offset:1024 lds
    v_mfma_f32_32x32x16_bf16 v[160:175], v[200:203], a[208:211], v[160:175]
    s_waitcnt lgkmcnt(4)
    ds_read_b64_tr_b16 v[216:217], v23 offset:18432
    ds_read_b64_tr_b16 v[218:219], v23 offset:19456
    buffer_load_dwordx4 v12, s[40:43], s62 offen offset:2048 lds
    v_mfma_f32_32x32x16_bf16 v[176:191], v[204:207], a[208:211], v[176:191]
    s_waitcnt lgkmcnt(4)
    ds_read_b64_tr_b16 v[220:221], v24 offset:18432
    ds_read_b64_tr_b16 v[222:223], v24 offset:19456
    v_mfma_f32_32x32x16_bf16 v[128:143], v[208:211], a[212:215], v[128:143]
    s_waitcnt lgkmcnt(4)
    ds_read_b64_tr_b16 v[192:193], v21 offset:20480
    ds_read_b64_tr_b16 v[194:195], v21 offset:21504
    buffer_load_dwordx4 v13, s[40:43], s62 offen offset:3072 lds
    v_mfma_f32_32x32x16_bf16 v[144:159], v[212:215], a[212:215], v[144:159]
    s_waitcnt lgkmcnt(4)
    ds_read_b64_tr_b16 v[196:197], v22 offset:20480
    ds_read_b64_tr_b16 v[198:199], v22 offset:21504
    v_mfma_f32_32x32x16_bf16 v[160:175], v[216:219], a[212:215], v[160:175]
    s_waitcnt lgkmcnt(4)
    ds_read_b64_tr_b16 v[200:201], v23 offset:20480
    ds_read_b64_tr_b16 v[202:203], v23 offset:21504
    v_mfma_f32_32x32x16_bf16 v[176:191], v[220:223], a[212:215], v[176:191]
    s_waitcnt lgkmcnt(4)
    ds_read_b64_tr_b16 v[204:205], v24 offset:20480
    ds_read_b64_tr_b16 v[206:207], v24 offset:21504
    v_mfma_f32_32x32x16_bf16 v[128:143], v[192:195], a[216:219], v[128:143]
    s_waitcnt lgkmcnt(4)
    ds_read_b64_tr_b16 v[208:209], v21 offset:22528
    ds_read_b64_tr_b16 v[210:211], v21 offset:23552
    v_mfma_f32_32x32x16_bf16 v[144:159], v[196:199], a[216:219], v[144:159]
    s_waitcnt lgkmcnt(4)
    ds_read_b64_tr_b16 v[212:213], v22 offset:22528
    ds_read_b64_tr_b16 v[214:215], v22 offset:23552
    v_mfma_f32_32x32x16_bf16 v[160:175], v[200:203], a[216:219], v[160:175]
    s_waitcnt lgkmcnt(4)
    ds_read_b64_tr_b16 v[216:217], v23 offset:22528
    ds_read_b64_tr_b16 v[218:219], v23 offset:23552
    v_mfma_f32_32x32x16_bf16 v[176:191], v[204:207], a[216:219], v[176:191]
    s_waitcnt lgkmcnt(4)
    s_waitcnt vmcnt(4)
    s_cmp_lg_u32 s10, 0
    s_cbranch_scc1 L_pf20
    buffer_wbl2 sc1
    s_waitcnt vmcnt(0)
    buffer_store_dword v48, off, s[48:51], s89 sc1
    s_branch L_pd21
L_pf20:
    buffer_store_dword v48, off, s[48:51], s89
L_pd21:
    ds_read_b64_tr_b16 v[220:221], v24 offset:22528
    ds_read_b64_tr_b16 v[222:223], v24 offset:23552
    v_mfma_f32_32x32x16_bf16 v[128:143], v[208:211], a[220:223], v[128:143]
    s_waitcnt lgkmcnt(4)
    ds_read_b64_tr_b16 v[192:193], v21 offset:32768
    ds_read_b64_tr_b16 v[194:195], v21 offset:33792
    v_mfma_f32_32x32x16_bf16 v[144:159], v[212:215], a[220:223], v[144:159]
    s_waitcnt lgkmcnt(4)
    ds_read_b64_tr_b16 v[196:197], v22 offset:32768
    ds_read_b64_tr_b16 v[198:199], v22 offset:33792
    v_mfma_f32_32x32x16_bf16 v[160:175], v[216:219], a[220:223], v[160:175]
    s_waitcnt lgkmcnt(4)
    ds_read_b64_tr_b16 v[200:201], v23 offset:32768
    ds_read_b64_tr_b16 v[202:203], v23 offset:33792
    v_mfma_f32_32x32x16_bf16 v[176:191], v[220:223], a[220:223], v[176:191]
    s_waitcnt lgkmcnt(4)
    ds_read_b64_tr_b16 v[204:205], v24 offset:32768
    ds_read_b64_tr_b16 v[206:207], v24 offset:33792
    v_mfma_f32_32x32x16_bf16 v[128:143], v[192:195], a[224:227], v[128:143]
    s_waitcnt lgkmcnt(4)
    s_barrier
    ds_read_b64_tr_b16 v[208:209], v21 offset:34816
    ds_read_b64_tr_b16 v[210:211], v21 offset:35840
    s_add_u32 s62, s23, 786432
    s_add_u32 m0, s13, 81920
    s_nop 0
    buffer_load_dwordx4 v10, s[40:43], s62 offen offset:0 lds
    v_mfma_f32_32x32x16_bf16 v[144:159], v[196:199], a[224:227], v[144:159]
    s_waitcnt lgkmcnt(4)
    ds_read_b64_tr_b16 v[212:213], v22 offset:34816
    ds_read_b64_tr_b16 v[214:215], v22 offset:35840
    buffer_load_dwordx4 v11, s[40:43], s62 offen offset:1024 lds
    v_mfma_f32_32x32x16_bf16 v[160:175], v[200:203], a[224:227], v[160:175]
    s_waitcnt lgkmcnt(4)
    ds_read_b64_tr_b16 v[216:217], v23 offset:34816
    ds_read_b64_tr_b16 v[218:219], v23 offset:35840
    buffer_load_dwordx4 v12, s[40:43], s62 offen offset:2048 lds
    v_mfma_f32_32x32x16_bf16 v[176:191], v[204:207], a[224:227], v[176:191]
    s_waitcnt lgkmcnt(4)
    ds_read_b64_tr_b16 v[220:221], v24 offset:34816
    ds_read_b64_tr_b16 v[222:223], v24 offset:35840
    v_mfma_f32_32x32x16_bf16 v[128:143], v[208:211], a[228:231], v[128:143]
    s_waitcnt lgkmcnt(4)
    ds_read_b64_tr_b16 v[192:193], v21 offset:36864
    ds_read_b64_tr_b16 v[194:195], v21 offset:37888
    buffer_load_dwordx4 v13, s[40:43], s62 offen offset:3072 lds
    v_mfma_f32_32x32x16_bf16 v[144:159], v[212:215], a[228:231], v[144:159]
    s_waitcnt lgkmcnt(4)
    ds_read_b64_tr_b16 v[196:197], v22 offset:36864
    ds_read_b64_tr_b16 v[198:199], v22 offset:37888
    v_mfma_f32_32x32x16_bf16 v[160:175], v[216:219], a[228:231], v[160:175]
    s_waitcnt lgkmcnt(4)
    ds_read_b64_tr_b16 v[200:201], v23 offset:36864
    ds_read_b64_tr_b16 v[202:203], v23 offset:37888
    v_mfma_f32_32x32x16_bf16 v[176:191], v[220:223], a[228:231], v[176:191]
    s_waitcnt lgkmcnt(4)
    buffer_load_dword v60, v57, s[48:51], 0 offen sc1
    ds_read_b64_tr_b16 v[204:205], v24 offset:36864
    ds_read_b64_tr_b16 v[206:207], v24 offset:37888
    v_mfma_f32_32x32x16_bf16 v[128:143], v[192:195], a[232:235], v[128:143]
    s_waitcnt lgkmcnt(4)
    ds_read_b64_tr_b16 v[208:209], v21 offset:38912
    ds_read_b64_tr_b16 v[210:211], v21 offset:39936
    v_mfma_f32_32x32x16_bf16 v[144:159], v[196:199], a[232:235], v[144:159]
    s_waitcnt lgkmcnt(4)
    ds_read_b64_tr_b16 v[212:213], v22 offset:38912
    ds_read_b64_tr_b16 v[214:215], v22 offset:39936
    v_mfma_f32_32x32x16_bf16 v[160:175], v[200:203], a[232:235], v[160:175]
    s_waitcnt lgkmcnt(4)
    ds_read_b64_tr_b16 v[216:217], v23 offset:38912
    ds_read_b64_tr_b16 v[218:219], v23 offset:39936
    v_mfma_f32_32x32x16_bf16 v[176:191], v[204:207], a[232:235], v[176:191]
    s_waitcnt lgkmcnt(4)
    ds_read_b64_tr_b16 v[220:221], v24 offset:38912
    ds_read_b64_tr_b16 v[222:223], v24 offset:39936
    v_mfma_f32_32x32x16_bf16 v[128:143], v[208:211], a[236:239], v[128:143]
    s_waitcnt lgkmcnt(4)
    ds_read_b64_tr_b16 v[192:193], v21 offset:49152
    ds_read_b64_tr_b16 v[194:195], v21 offset:50176
    v_mfma_f32_32x32x16_bf16 v[144:159], v[212:215], a[236:239], v[144:159]
    s_waitcnt lgkmcnt(4)
    ds_read_b64_tr_b16 v[196:197], v21 offset:51200
    ds_read_b64_tr_b16 v[198:199], v21 offset:52224
    v_mfma_f32_32x32x16_bf16 v[160:175], v[216:219], a[236:239], v[160:175]
    s_waitcnt lgkmcnt(4)
    ds_read_b64_tr_b16 v[200:201], v21 offset:53248
    ds_read_b64_tr_b16 v[202:203], v21 offset:54272
    v_mfma_f32_32x32x16_bf16 v[176:191], v[220:223], a[236:239], v[176:191]
    s_waitcnt lgkmcnt(4)
    ds_read_b64_tr_b16 v[204:205], v21 offset:55296
    ds_read_b64_tr_b16 v[206:207], v21 offset:56320
    v_mfma_f32_32x32x16_bf16 v[128:143], v[192:195], a[240:243], v[128:143]
    s_waitcnt lgkmcnt(4)
    s_barrier
    ds_read_b64_tr_b16 v[208:209], v22 offset:49152
    ds_read_b64_tr_b16 v[210:211], v22 offset:50176
    s_add_u32 s62, s80, 0
    s_add_u32 m0, s13, 98304
    s_nop 0
    buffer_load_dwordx4 v10, s[40:43], s62 offen offset:0 lds
    v_mfma_f32_32x32x16_bf16 v[128:143], v[196:199], a[244:247], v[128:143]
    s_waitcnt lgkmcnt(4)
    ds_read_b64_tr_b16 v[212:213], v22 offset:51200
    ds_read_b64_tr_b16 v[214:215], v22 offset:52224
    buffer_load_dwordx4 v11, s[40:43], s62 offen offset:1024 lds
    v_mfma_f32_32x32x16_bf16 v[128:143], v[200:203], a[248:251], v[128:143]
    s_waitcnt lgkmcnt(4)
    ds_read_b64_tr_b16 v[216:217], v22 offset:53248
    ds_read_b64_tr_b16 v[218:219], v22 offset:54272
    buffer_load_dwordx4 v12, s[40:43], s62 offen offset:2048 lds
    v_mfma_f32_32x32x16_bf16 v[128:143], v[204:207], a[252:255], v[128:143]
    s_waitcnt lgkmcnt(4)
    ds_read_b64_tr_b16 v[220:221], v22 offset:55296
    ds_read_b64_tr_b16 v[222:223], v22 offset:56320
    v_mfma_f32_32x32x16_bf16 v[144:159], v[208:211], a[240:243], v[144:159]
    s_waitcnt lgkmcnt(4)
    ds_read_b64_tr_b16 v[192:193], v23 offset:49152
    ds_read_b64_tr_b16 v[194:195], v23 offset:50176
    buffer_load_dwordx4 v13, s[40:43], s62 offen offset:3072 lds
    v_mfma_f32_32x32x16_bf16 v[144:159], v[212:215], a[244:247], v[144:159]
    s_waitcnt lgkmcnt(4)
    ds_read_b64_tr_b16 v[196:197], v23 offset:51200
    ds_read_b64_tr_b16 v[198:199], v23 offset:52224
    v_mfma_f32_32x32x16_bf16 v[144:159], v[216:219], a[248:251], v[144:159]
    s_waitcnt lgkmcnt(4)
    ds_read_b64_tr_b16 v[200:201], v23 offset:53248
    ds_read_b64_tr_b16 v[202:203], v23 offset:54272
    s_xor_b32 s86, s88, 0
    v_mul_f32 v128, v128, v136
    v_mul_f32 v129, v129, v137
    v_mul_f32 v130, v130, v138
    v_mfma_f32_32x32x16_bf16 v[144:159], v[220:223], a[252:255], v[144:159]
    s_waitcnt lgkmcnt(4)
    s_waitcnt vmcnt(4)
    v_xor_b32 v60, v60, v48
    v_cmp_lt_u32 vcc, 15, v60
    s_cmp_eq_u32 s10, 0
    s_cbranch_scc1 L_spin22
    s_cbranch_vccnz L_spin22
L_back23:
    ds_read_b64_tr_b16 v[204:205], v23 offset:55296
    ds_read_b64_tr_b16 v[206:207], v23 offset:56320
    v_mfma_f32_32x32x16_bf16 v[160:175], v[192:195], a[240:243], v[160:175]
    s_waitcnt lgkmcnt(4)
    ds_read_b64_tr_b16 v[208:209], v24 offset:49152
    ds_read_b64_tr_b16 v[210:211], v24 offset:50176
    s_add_u32 s70, s81, 0
    buffer_load_dwordx4 a[0:3], v1, s[48:51], s70 offen offset:0 sc1
    v_mul_f32 v131, v131, v139
    v_mfma_f32_32x32x16_bf16 v[160:175], v[196:199], a[244:247], v[160:175]
    s_waitcnt lgkmcnt(4)
    ds_read_b64_tr_b16 v[212:213], v24 offset:51200
    ds_read_b64_tr_b16 v[214:215], v24 offset:52224
    buffer_load_dwordx4 a[4:7], v1, s[48:51], s70 offen offset:1024 sc1
    v_mul_f32 v132, v132, v140
    v_mul_f32 v133, v133, v141
    v_mfma_f32_32x32x16_bf16 v[160:175], v[200:203], a[248:251], v[160:175]
    s_waitcnt lgkmcnt(4)
    ds_read_b64_tr_b16 v[216:217], v24 offset:53248
    ds_read_b64_tr_b16 v[218:219], v24 offset:54272
    buffer_load_dwordx4 a[8:11], v1, s[48:51], s70 offen offset:2048 sc1
    v_mul_f32 v134, v134, v142
    v_mul_f32 v135, v135, v143
    v_mfma_f32_32x32x16_bf16 v[160:175], v[204:207], a[252:255], v[160:175]
    s_waitcnt lgkmcnt(4)
    ds_read_b64_tr_b16 v[220:221], v24 offset:55296
    ds_read_b64_tr_b16 v[222:223], v24 offset:56320
    v_cvt_pk_bf16_f32 v136, v128, v129
    v_cvt_pk_bf16_f32 v137, v130, v131
    v_cvt_pk_bf16_f32 v138, v132, v133
    v_cvt_pk_bf16_f32 v139, v134, v135
    v_mfma_f32_32x32x16_bf16 v[176:191], v[208:211], a[240:243], v[176:191]
    s_waitcnt lgkmcnt(4)
    buffer_load_dwordx4 a[12:15], v1, s[48:51], s70 offen offset:3072 sc1
    s_add_u32 s70, s81, 8192
    buffer_store_dwordx4 v[136:139], v1, s[48:51], s86 offen sc1
    v_mfma_f32_32x32x16_bf16 v[176:191], v[212:215], a[244:247], v[176:191]
    s_waitcnt lgkmcnt(2)
    s_xor_b32 s86, s88, 1024
    v_mul_f32 v144, v144, v152
    v_mul_f32 v145, v145, v153
    v_mul_f32 v146, v146, v154
    v_mul_f32 v147, v147, v155
    v_mul_f32 v148, v148, v156
    v_mfma_f32_32x32x16_bf16 v[176:191], v[216:219], a[248:251], v[176:191]
    s_waitcnt lgkmcnt(0)
    buffer_load_dwordx4 a[16:19], v1, s[48:51], s70 offen offset:0 sc1
    v_mul_f32 v149, v149, v157
    v_mul_f32 v150, v150, v158
    v_mul_f32 v151, v151, v159
    v_cvt_pk_bf16_f32 v152, v144, v145
    v_mfma_f32_32x32x16_bf16 v[176:191], v[220:223], a[252:255], v[176:191]
    v_cvt_pk_bf16_f32 v153, v146, v147
    v_cvt_pk_bf16_f32 v154, v148, v149
    v_cvt_pk_bf16_f32 v155, v150, v151
    buffer_store_dwordx4 v[152:155], v1, s[48:51], s86 offen sc1
    s_barrier
    s_xor_b32 s86, s88, 2048
    v_mul_f32 v160, v160, v168
    v_mul_f32 v161, v161, v169
    v_mul_f32 v162, v162, v170
    buffer_load_dwordx4 a[20:23], v1, s[48:51], s70 offen offset:1024 sc1
    v_mul_f32 v163, v163, v171
    v_mul_f32 v164, v164, v172
    v_mul_f32 v165, v165, v173
    v_mul_f32 v166, v166, v174
    v_mul_f32 v167, v167, v175
    v_cvt_pk_bf16_f32 v168, v160, v161
    v_cvt_pk_bf16_f32 v169, v162, v163
    v_cvt_pk_bf16_f32 v170, v164, v165
    v_cvt_pk_bf16_f32 v171, v166, v167
    buffer_store_dwordx4 v[168:171], v1, s[48:51], s86 offen sc1
    s_xor_b32 s86, s88, 3072
    v_mul_f32 v176, v176, v184
    v_mul_f32 v177, v177, v185
    buffer_load_dwordx4 a[24:27], v1, s[48:51], s70 offen offset:2048 sc1
    v_mul_f32 v178, v178, v186
    v_mul_f32 v179, v179, v187
    v_mul_f32 v180, v180, v188
    v_mul_f32 v181, v181, v189
    v_mul_f32 v182, v182, v190
    v_mul_f32 v183, v183, v191
    v_cvt_pk_bf16_f32 v184, v176, v177
    v_cvt_pk_bf16_f32 v185, v178, v179
    v_cvt_pk_bf16_f32 v186, v180, v181
    v_cvt_pk_bf16_f32 v187, v182, v183
    buffer_store_dwordx4 v[184:187], v1, s[48:51], s86 offen sc1
    buffer_load_dwordx4 a[28:31], v1, s[48:51], s70 offen offset:3072 sc1
L_down:
    s_barrier
    ds_read_b64_tr_b16 v[192:193], v30 offset:0
    ds_read_b64_tr_b16 v[194:195], v30 offset:1024
    ds_read_b64_tr_b16 v[196:197], v29 offset:0
    ds_read_b64_tr_b16 v[198:199], v29 offset:1024
    ds_read_b64_tr_b16 v[200:201], v30 offset:2048
    ds_read_b64_tr_b16 v[202:203], v30 offset:3072
    ds_read_b64_tr_b16 v[204:205], v29 offset:2048
    ds_read_b64_tr_b16 v[206:207], v29 offset:3072
    s_waitcnt vmcnt(11) lgkmcnt(6)
    v_mfma_f32_32x32x16_bf16 v[80:95], v[192:195], a[0:3], 0
    s_waitcnt lgkmcnt(4)
    ds_read_b64_tr_b16 v[208:209], v30 offset:4096
    ds_read_b64_tr_b16 v[210:211], v30 offset:5120
    s_add_u32 s70, s81, 16384
    buffer_load_dwordx4 a[32:35], v1, s[48:51], s70 offen offset:0 sc1
    v_mfma_f32_32x32x16_bf16 v[64:79], v[196:199], a[0:3], 0
    s_waitcnt vmcnt(11) lgkmcnt(4)
    ds_read_b64_tr_b16 v[212:213], v29 offset:4096
    ds_read_b64_tr_b16 v[214:215], v29 offset:5120
    buffer_load_dwordx4 a[36:39], v1, s[48:51], s70 offen offset:1024 sc1
    buffer_load_dwordx4 a[40:43], v1, s[48:51], s70 offen offset:2048 sc1
    v_mfma_f32_32x32x16_bf16 v[80:95], v[200:203], a[4:7], v[80:95]
    s_waitcnt lgkmcnt(4)
    ds_read_b64_tr_b16 v[216:217], v30 offset:6144
    ds_read_b64_tr_b16 v[218:219], v30 offset:7168
    buffer_load_dwordx4 a[44:47], v1, s[48:51], s70 offen offset:3072 sc1
    s_add_u32 s70, s81, 24576
    v_mfma_f32_32x32x16_bf16 v[64:79], v[204:207], a[4:7], v[64:79]
    s_waitcnt vmcnt(13) lgkmcnt(4)
    ds_read_b64_tr_b16 v[220:221], v29 offset:6144
    ds_read_b64_tr_b16 v[222:223], v29 offset:7168
    buffer_load_dwordx4 a[48:51], v1, s[48:51], s70 offen offset:0 sc1
    buffer_load_dwordx4 a[52:55], v1, s[48:51], s70 offen offset:1024 sc1
    v_mfma_f32_32x32x16_bf16 v[80:95], v[208:211], a[8:11], v[80:95]
    s_waitcnt lgkmcnt(4)
    ds_read_b64_tr_b16 v[192:193], v26 offset:0
    ds_read_b64_tr_b16 v[194:195], v26 offset:1024
    buffer_load_dwordx4 a[56:59], v1, s[48:51], s70 offen offset:2048 sc1
    v_mfma_f32_32x32x16_bf16 v[64:79], v[212:215], a[8:11], v[64:79]
    s_waitcnt vmcnt(15) lgkmcnt(4)
    ds_read_b64_tr_b16 v[196:197], v25 offset:0
    ds_read_b64_tr_b16 v[198:199], v25 offset:1024
    v_mfma_f32_32x32x16_bf16 v[80:95], v[216:219], a[12:15], v[80:95]
    s_waitcnt lgkmcnt(4)
    ds_read_b64_tr_b16 v[200:201], v26 offset:2048
    ds_read_b64_tr_b16 v[202:203], v26 offset:3072
    buffer_load_dwordx4 a[60:63], v1, s[48:51], s70 offen offset:3072 sc1
    s_add_u32 s70, s81, 32768
    v_mfma_f32_32x32x16_bf16 v[64:79], v[220:223], a[12:15], v[64:79]
    s_waitcnt vmcnt(14) lgkmcnt(4)
    ds_read_b64_tr_b16 v[204:205], v25 offset:2048
    ds_read_b64_tr_b16 v[206:207], v25 offset:3072
    v_mfma_f32_32x32x16_bf16 v[80:95], v[192:195], a[16:19], v[80:95]
    s_waitcnt lgkmcnt(4)
    ds_read_b64_tr_b16 v[208:209], v26 offset:4096
    ds_read_b64_tr_b16 v[210:211], v26 offset:5120
    buffer_load_dwordx4 a[64:67], v1, s[48:51], s70 offen offset:0 sc1
    s_add_u32 s62, s80, 131072
    v_mfma_f32_32x32x16_bf16 v[64:79], v[196:199], a[16:19], v[64:79]
    s_waitcnt vmcnt(13) lgkmcnt(4)
    ds_read_b64_tr_b16 v[212:213], v25 offset:4096
    ds_read_b64_tr_b16 v[214:215], v25 offset:5120
    v_mfma_f32_32x32x16_bf16 v[80:95], v[200:203], a[20:23], v[80:95]
    s_waitcnt lgkmcnt(4)
    ds_read_b64_tr_b16 v[216:217], v26 offset:6144
    ds_read_b64_tr_b16 v[218:219], v26 offset:7168
    s_add_u32 m0, s13, 114688
    s_nop 0
    buffer_load_dwordx4 v10, s[40:43], s62 offen offset:0 lds
    v_mfma_f32_32x32x16_bf16 v[64:79], v[204:207], a[20:23], v[64:79]
    s_waitcnt vmcnt(12) lgkmcnt(4)
    ds_read_b64_tr_b16 v[220:221], v25 offset:6144
    ds_read_b64_tr_b16 v[222:223], v25 offset:7168
    buffer_load_dwordx4 v11, s[40:43], s62 offen offset:1024 lds
    buffer_load_dwordx4 v12, s[40:43], s62 offen offset:2048 lds
    v_mfma_f32_32x32x16_bf16 v[80:95], v[208:211], a[24:27], v[80:95]
    s_waitcnt lgkmcnt(4)
    s_barrier
    ds_read_b64_tr_b16 v[192:193], v26 offset:16384
    ds_read_b64_tr_b16 v[194:195], v26 offset:17408
    buffer_load_dwordx4 v13, s[40:43], s62 offen offset:3072 lds
    v_mfma_f32_32x32x16_bf16 v[64:79], v[212:215], a[24:27], v[64:79]
    s_waitcnt vmcnt(13) lgkmcnt(4)
    ds_read_b64_tr_b16 v[196:197], v25 offset:16384
    ds_read_b64_tr_b16 v[198:199], v25 offset:17408
    buffer_load_dwordx4 a[68:71], v1, s[48:51], s70 offen offset:1024 sc1
    buffer_load_dwordx4 a[72:75], v1, s[48:51], s70 offen offset:2048 sc1
    v_mfma_f32_32x32x16_bf16 v[80:95], v[216:219], a[28:31], v[80:95]
    s_waitcnt lgkmcnt(4)
    ds_read_b64_tr_b16 v[200:201], v26 offset:18432
    ds_read_b64_tr_b16 v[202:203], v26 offset:19456
    buffer_load_dwordx4 a[76:79], v1, s[48:51], s70 offen offset:3072 sc1
    s_add_u32 s70, s81, 40960
    v_mfma_f32_32x32x16_bf16 v[64:79], v[220:223], a[28:31], v[64:79]
    s_waitcnt vmcnt(15) lgkmcnt(4)
    ds_read_b64_tr_b16 v[204:205], v25 offset:18432
    ds_read_b64_tr_b16 v[206:207], v25 offset:19456
    v_mfma_f32_32x32x16_bf16 v[80:95], v[192:195], a[32:35], v[80:95]
    s_waitcnt lgkmcnt(4)
    s_cmp_ge_u32 s5, 28
    s_cbranch_scc1 L_np24
    s_cmp_lg_u32 s10, 0
    s_cbranch_scc1 L_pf25
    buffer_wbl2 sc1
    s_waitcnt vmcnt(0)
    buffer_store_dword v48, off, s[48:51], s90 sc1
    s_branch L_pd26
L_pf25:
    buffer_store_dword v48, off, s[48:51], s90
L_pd26:
L_np24:
    ds_read_b64_tr_b16 v[208:209], v26 offset:20480
    ds_read_b64_tr_b16 v[210:211], v26 offset:21504
    buffer_load_dwordx4 a[80:83], v1, s[48:51], s70 offen offset:0 sc1
    v_mfma_f32_32x32x16_bf16 v[64:79], v[196:199], a[32:35], v[64:79]
    s_waitcnt vmcnt(15) lgkmcnt(4)
    ds_read_b64_tr_b16 v[212:213], v25 offset:20480
    ds_read_b64_tr_b16 v[214:215], v25 offset:21504
    s_add_u32 s62, s80, 262144
    v_mfma_f32_32x32x16_bf16 v[80:95], v[200:203], a[36:39], v[80:95]
    s_waitcnt lgkmcnt(4)
    ds_read_b64_tr_b16 v[216:217], v26 offset:22528
    ds_read_b64_tr_b16 v[218:219], v26 offset:23552
    s_add_u32 m0, s13, 131072
    s_nop 0
    buffer_load_dwordx4 v10, s[40:43], s62 offen offset:0 lds
    v_mfma_f32_32x32x16_bf16 v[64:79], v[204:207], a[36:39], v[64:79]
    s_waitcnt vmcnt(15) lgkmcnt(4)
    ds_read_b64_tr_b16 v[220:221], v25 offset:22528
    ds_read_b64_tr_b16 v[222:223], v25 offset:23552
    buffer_load_dwordx4 v11, s[40:43], s62 offen offset:1024 lds
    buffer_load_dwordx4 v12, s[40:43], s62 offen offset:2048 lds
    v_mfma_f32_32x32x16_bf16 v[80:95], v[208:211], a[40:43], v[80:95]
    s_waitcnt lgkmcnt(4)
    s_barrier
    ds_read_b64_tr_b16 v[192:193], v26 offset:32768
    ds_read_b64_tr_b16 v[194:195], v26 offset:33792
    buffer_load_dwordx4 v13, s[40:43], s62 offen offset:3072 lds
    v_mfma_f32_32x32x16_bf16 v[64:79], v[212:215], a[40:43], v[64:79]
    s_waitcnt vmcnt(17) lgkmcnt(4)
    ds_read_b64_tr_b16 v[196:197], v25 offset:32768
    ds_read_b64_tr_b16 v[198:199], v25 offset:33792
    buffer_load_dwordx4 a[84:87], v1, s[48:51], s70 offen offset:1024 sc1
    buffer_load_dwordx4 a[88:91], v1, s[48:51], s70 offen offset:2048 sc1
    v_mfma_f32_32x32x16_bf16 v[80:95], v[216:219], a[44:47], v[80:95]
    s_waitcnt lgkmcnt(4)
    ds_read_b64_tr_b16 v[200:201], v26 offset:34816
    ds_read_b64_tr_b16 v[202:203], v26 offset:35840
    buffer_load_dwordx4 a[92:95], v1, s[48:51], s70 offen offset:3072 sc1
    s_add_u32 s70, s81, 49152
    v_mfma_f32_32x32x16_bf16 v[64:79], v[220:223], a[44:47], v[64:79]
    s_waitcnt vmcnt(19) lgkmcnt(4)
    ds_read_b64_tr_b16 v[204:205], v25 offset:34816
    ds_read_b64_tr_b16 v[206:207], v25 offset:35840
    v_mfma_f32_32x32x16_bf16 v[80:95], v[192:195], a[48:51], v[80:95]
    s_waitcnt lgkmcnt(4)
    ds_read_b64_tr_b16 v[208:209], v26 offset:36864
    ds_read_b64_tr_b16 v[210:211], v26 offset:37888
    buffer_load_dwordx4 a[96:99], v1, s[48:51], s70 offen offset:0 sc1
    s_add_u32 s62, s80, 393216
    v_mfma_f32_32x32x16_bf16 v[64:79], v[196:199], a[48:51], v[64:79]
    s_waitcnt vmcnt(19) lgkmcnt(4)
    ds_read_b64_tr_b16 v[212:213], v25 offset:36864
    ds_read_b64_tr_b16 v[214:215], v25 offset:37888
    v_mfma_f32_32x32x16_bf16 v[80:95], v[200:203], a[52:55], v[80:95]
    s_waitcnt lgkmcnt(4)
    buffer_load_dword v60, v58, s[48:51], 0 offen sc1
    ds_read_b64_tr_b16 v[216:217], v26 offset:38912
    ds_read_b64_tr_b16 v[218:219], v26 offset:39936
    s_add_u32 m0, s13, 0
    s_nop 0
    buffer_load_dwordx4 v10, s[40:43], s62 offen offset:0 lds
    v_mfma_f32_32x32x16_bf16 v[64:79], v[204:207], a[52:55], v[64:79]
    s_waitcnt vmcnt(20) lgkmcnt(4)
    ds_read_b64_tr_b16 v[220:221], v25 offset:38912
    ds_read_b64_tr_b16 v[222:223], v25 offset:39936
    buffer_load_dwordx4 v11, s[40:43], s62 offen offset:1024 lds
    buffer_load_dwordx4 v12, s[40:43], s62 offen offset:2048 lds
    v_mfma_f32_32x32x16_bf16 v[80:95], v[208:211], a[56:59], v[80:95]
    s_waitcnt lgkmcnt(4)
    s_barrier
    ds_read_b64_tr_b16 v[192:193], v26 offset:49152
    ds_read_b64_tr_b16 v[194:195], v26 offset:50176
    buffer_load_dwordx4 v13, s[40:43], s62 offen offset:3072 lds
    v_mfma_f32_32x32x16_bf16 v[64:79], v[212:215], a[56:59], v[64:79]
    s_waitcnt vmcnt(22) lgkmcnt(4)
    ds_read_b64_tr_b16 v[196:197], v25 offset:49152
    ds_read_b64_tr_b16 v[198:199], v25 offset:50176
    buffer_load_dwordx4 a[100:103], v1, s[48:51], s70 offen offset:1024 sc1
    buffer_load_dwordx4 a[104:107], v1, s[48:51], s70 offen offset:2048 sc1
    v_mfma_f32_32x32x16_bf16 v[80:95], v[216:219], a[60:63], v[80:95]
    s_waitcnt lgkmcnt(4)
    ds_read_b64_tr_b16 v[200:201], v26 offset:51200
    ds_read_b64_tr_b16 v[202:203], v26 offset:52224
    buffer_load_dwordx4 a[108:111], v1, s[48:51], s70 offen offset:3072 sc1
    s_add_u32 s62, s80, 524288
    v_mfma_f32_32x32x16_bf16 v[64:79], v[220:223], a[60:63], v[64:79]
    s_waitcnt vmcnt(24) lgkmcnt(4)
    ds_read_b64_tr_b16 v[204:205], v25 offset:51200
    ds_read_b64_tr_b16 v[206:207], v25 offset:52224
    v_mfma_f32_32x32x16_bf16 v[80:95], v[192:195], a[64:67], v[80:95]
    s_waitcnt lgkmcnt(4)
    ds_read_b64_tr_b16 v[208:209], v26 offset:53248
    ds_read_b64_tr_b16 v[210:211], v26 offset:54272
    v_mfma_f32_32x32x16_bf16 v[64:79], v[196:199], a[64:67], v[64:79]
    s_waitcnt vmcnt(19) lgkmcnt(4)
    ds_read_b64_tr_b16 v[212:213], v25 offset:53248
    ds_read_b64_tr_b16 v[214:215], v25 offset:54272
    v_mfma_f32_32x32x16_bf16 v[80:95], v[200:203], a[68:71], v[80:95]
    s_waitcnt lgkmcnt(4)
    ds_read_b64_tr_b16 v[216:217], v26 offset:55296
    ds_read_b64_tr_b16 v[218:219], v26 offset:56320
    s_add_u32 m0, s13, 16384
    s_nop 0
    buffer_load_dwordx4 v10, s[40:43], s62 offen offset:0 lds
    v_mfma_f32_32x32x16_bf16 v[64:79], v[204:207], a[68:71], v[64:79]
    s_waitcnt vmcnt(19) lgkmcnt(4)
    ds_read_b64_tr_b16 v[220:221], v25 offset:55296
    ds_read_b64_tr_b16 v[222:223], v25 offset:56320
    buffer_load_dwordx4 v11, s[40:43], s62 offen offset:1024 lds
    buffer_load_dwordx4 v12, s[40:43], s62 offen offset:2048 lds
    v_mfma_f32_32x32x16_bf16 v[80:95], v[208:211], a[72:75], v[80:95]
    s_waitcnt lgkmcnt(4)
    s_barrier
    ds_read_b64_tr_b16 v[192:193], v28 offset:0
    ds_read_b64_tr_b16 v[194:195], v28 offset:1024
    buffer_load_dwordx4 v13, s[40:43], s62 offen offset:3072 lds
    s_add_u32 s62, s80, 655360
    v_mfma_f32_32x32x16_bf16 v[64:79], v[212:215], a[72:75], v[64:79]
    s_waitcnt vmcnt(21) lgkmcnt(4)
    ds_read_b64_tr_b16 v[196:197], v27 offset:0
    ds_read_b64_tr_b16 v[198:199], v27 offset:1024
    v_mfma_f32_32x32x16_bf16 v[80:95], v[216:219], a[76:79], v[80:95]
    s_waitcnt lgkmcnt(4)
    s_waitcnt vmcnt(11)
    v_xor_b32 v60, v60, v48
    v_cmp_lt_u32 vcc, 15, v60
    s_cmp_eq_u32 s10, 0
    s_cbranch_scc1 L_spin27
    s_cbranch_vccnz L_spin27
L_back28:
    ds_read_b64_tr_b16 v[200:201], v28 offset:2048
    ds_read_b64_tr_b16 v[202:203], v28 offset:3072
    v_mfma_f32_32x32x16_bf16 v[64:79], v[220:223], a[76:79], v[64:79]
    s_waitcnt lgkmcnt(4)
    ds_read_b64_tr_b16 v[204:205], v27 offset:2048
    ds_read_b64_tr_b16 v[206:207], v27 offset:3072
    s_add_u32 s71, s82, 0
    buffer_load_dwordx4 a[128:131], v1, s[48:51], s71 offen offset:0 sc1
    v_mfma_f32_32x32x16_bf16 v[80:95], v[192:195], a[80:83], v[80:95]
    s_waitcnt lgkmcnt(4)
    ds_read_b64_tr_b16 v[208:209], v28 offset:4096
    ds_read_b64_tr_b16 v[210:211], v28 offset:5120
    buffer_load_dwordx4 a[132:135], v1, s[48:51], s71 offen offset:1024 sc1
    buffer_load_dwordx4 a[136:139], v1, s[48:51], s71 offen offset:2048 sc1
    v_mfma_f32_32x32x16_bf16 v[64:79], v[196:199], a[80:83], v[64:79]
    s_waitcnt lgkmcnt(4)
    ds_read_b64_tr_b16 v[212:213], v27 offset:4096
    ds_read_b64_tr_b16 v[214:215], v27 offset:5120
    buffer_load_dwordx4 a[140:143], v1, s[48:51], s71 offen offset:3072 sc1
    s_add_u32 s71, s82, 8192
    v_mfma_f32_32x32x16_bf16 v[80:95], v[200:203], a[84:87], v[80:95]
    s_waitcnt lgkmcnt(4)
    ds_read_b64_tr_b16 v[216:217], v28 offset:6144
    ds_read_b64_tr_b16 v[218:219], v28 offset:7168
    buffer_load_dwordx4 a[144:147], v1, s[48:51], s71 offen offset:0 sc1
    s_add_u32 m0, s13, 32768
    s_nop 0
    buffer_load_dwordx4 v10, s[40:43], s62 offen offset:0 lds
    v_mfma_f32_32x32x16_bf16 v[64:79], v[204:207], a[84:87], v[64:79]
    s_waitcnt lgkmcnt(4)
    ds_read_b64_tr_b16 v[220:221], v27 offset:6144
    ds_read_b64_tr_b16 v[222:223], v27 offset:7168
    buffer_load_dwordx4 v11, s[40:43], s62 offen offset:1024 lds
    buffer_load_dwordx4 v12, s[40:43], s62 offen offset:2048 lds
    v_mfma_f32_32x32x16_bf16 v[80:95], v[208:211], a[88:91], v[80:95]
    s_waitcnt lgkmcnt(4)
    s_barrier
    ds_read_b64_tr_b16 v[192:193], v28 offset:16384
    ds_read_b64_tr_b16 v[194:195], v28 offset:17408
    buffer_load_dwordx4 v13, s[40:43], s62 offen offset:3072 lds
    v_mfma_f32_32x32x16_bf16 v[64:79], v[212:215], a[88:91], v[64:79]
    s_waitcnt lgkmcnt(4)
    ds_read_b64_tr_b16 v[196:197], v27 offset:16384
    ds_read_b64_tr_b16 v[198:199], v27 offset:17408
    buffer_load_dwordx4 a[148:151], v1, s[48:51], s71 offen offset:1024 sc1
    buffer_load_dwordx4 a[152:155], v1, s[48:51], s71 offen offset:2048 sc1
    v_mfma_f32_32x32x16_bf16 v[80:95], v[216:219], a[92:95], v[80:95]
    s_waitcnt lgkmcnt(4)
    ds_read_b64_tr_b16 v[200:201], v28 offset:18432
    ds_read_b64_tr_b16 v[202:203], v28 offset:19456
    buffer_load_dwordx4 a[156:159], v1, s[48:51], s71 offen offset:3072 sc1
    s_add_u32 s71, s82, 16384
    v_mfma_f32_32x32x16_bf16 v[64:79], v[220:223], a[92:95], v[64:79]
    s_waitcnt lgkmcnt(4)
    ds_read_b64_tr_b16 v[204:205], v27 offset:18432
    ds_read_b64_tr_b16 v[206:207], v27 offset:19456
    v_mfma_f32_32x32x16_bf16 v[80:95], v[192:195], a[96:99], v[80:95]
    s_waitcnt lgkmcnt(4)
    ds_read_b64_tr_b16 v[208:209], v28 offset:20480
    ds_read_b64_tr_b16 v[210:211], v28 offset:21504
    buffer_load_dwordx4 a[160:163], v1, s[48:51], s71 offen offset:0 sc1
    s_add_u32 s62, s80, 786432
    v_mfma_f32_32x32x16_bf16 v[64:79], v[196:199], a[96:99], v[64:79]
    s_waitcnt vmcnt(19) lgkmcnt(4)
    ds_read_b64_tr_b16 v[212:213], v27 offset:20480
    ds_read_b64_tr_b16 v[214:215], v27 offset:21504
    v_mfma_f32_32x32x16_bf16 v[80:95], v[200:203], a[100:103], v[80:95]
    s_waitcnt lgkmcnt(4)
    ds_read_b64_tr_b16 v[216:217], v28 offset:22528
    ds_read_b64_tr_b16 v[218:219], v28 offset:23552
    s_add_u32 m0, s13, 49152
    s_nop 0
    buffer_load_dwordx4 v10, s[40:43], s62 offen offset:0 lds
    v_mfma_f32_32x32x16_bf16 v[64:79], v[204:207], a[100:103], v[64:79]
    s_waitcnt vmcnt(19) lgkmcnt(4)
    ds_read_b64_tr_b16 v[220:221], v27 offset:22528
    ds_read_b64_tr_b16 v[222:223], v27 offset:23552
    buffer_load_dwordx4 v11, s[40:43], s62 offen offset:1024 lds
    buffer_load_dwordx4 v12, s[40:43], s62 offen offset:2048 lds
    v_mfma_f32_32x32x16_bf16 v[80:95], v[208:211], a[104:107], v[80:95]
    s_waitcnt lgkmcnt(4)
    ds_read_b64_tr_b16 v[192:193], v28 offset:32768
    ds_read_b64_tr_b16 v[194:195], v28 offset:33792
    buffer_load_dwordx4 v13, s[40:43], s62 offen offset:3072 lds
    buffer_load_dwordx4 a[164:167], v1, s[48:51], s71 offen offset:1024 sc1
    v_mfma_f32_32x32x16_bf16 v[64:79], v[212:215], a[104:107], v[64:79]
    s_waitcnt vmcnt(22) lgkmcnt(4)
    ds_read_b64_tr_b16 v[196:197], v27 offset:32768
    ds_read_b64_tr_b16 v[198:199], v27 offset:33792
    buffer_load_dwordx4 a[168:171], v1, s[48:51], s71 offen offset:2048 sc1
    v_mfma_f32_32x32x16_bf16 v[80:95], v[216:219], a[108:111], v[80:95]
    s_waitcnt lgkmcnt(4)
    ds_read_b64_tr_b16 v[200:201], v28 offset:34816
    ds_read_b64_tr_b16 v[202:203], v28 offset:35840
    buffer_load_dwordx4 a[172:175], v1, s[48:51], s71 offen offset:3072 sc1
    s_add_u32 s71, s82, 24576
    v_mfma_f32_32x32x16_bf16 v[64:79], v[220:223], a[108:111], v[64:79]
    s_waitcnt vmcnt(19) lgkmcnt(4)
    ds_read_b64_tr_b16 v[204:205], v27 offset:34816
    ds_read_b64_tr_b16 v[206:207], v27 offset:35840
    v_mfma_f32_32x32x16_bf16 v[80:95], v[192:195], a[128:131], v[80:95]
    s_waitcnt lgkmcnt(4)
    ds_read_b64_tr_b16 v[208:209], v28 offset:36864
    ds_read_b64_tr_b16 v[210:211], v28 offset:37888
    buffer_load_dwordx4 a[176:179], v1, s[48:51], s71 offen offset:0 sc1
    v_mfma_f32_32x32x16_bf16 v[64:79], v[196:199], a[128:131], v[64:79]
    s_waitcnt vmcnt(19) lgkmcnt(4)
    ds_read_b64_tr_b16 v[212:213], v27 offset:36864
    ds_read_b64_tr_b16 v[214:215], v27 offset:37888
    v_mfma_f32_32x32x16_bf16 v[80:95], v[200:203], a[132:135], v[80:95]
    s_waitcnt lgkmcnt(4)
    ds_read_b64_tr_b16 v[216:217], v28 offset:38912
    ds_read_b64_tr_b16 v[218:219], v28 offset:39936
    buffer_load_dwordx4 a[180:183], v1, s[48:51], s71 offen offset:1024 sc1
    v_mfma_f32_32x32x16_bf16 v[64:79], v[204:207], a[132:135], v[64:79]
    s_waitcnt vmcnt(19) lgkmcnt(4)
    ds_read_b64_tr_b16 v[220:221], v27 offset:38912
    ds_read_b64_tr_b16 v[222:223], v27 offset:39936
    v_mfma_f32_32x32x16_bf16 v[80:95], v[208:211], a[136:139], v[80:95]
    s_waitcnt lgkmcnt(4)
    ds_read_b64_tr_b16 v[192:193], v28 offset:49152
    ds_read_b64_tr_b16 v[194:195], v28 offset:50176
    buffer_load_dwordx4 a[184:187], v1, s[48:51], s71 offen offset:2048 sc1
    v_mfma_f32_32x32x16_bf16 v[64:79], v[212:215], a[136:139], v[64:79]
    s_waitcnt vmcnt(19) lgkmcnt(4)
    ds_read_b64_tr_b16 v[196:197], v27 offset:49152
    ds_read_b64_tr_b16 v[198:199], v27 offset:50176
    v_mfma_f32_32x32x16_bf16 v[80:95], v[216:219], a[140:143], v[80:95]
    s_waitcnt lgkmcnt(4)
    ds_read_b64_tr_b16 v[200:201], v28 offset:51200
    ds_read_b64_tr_b16 v[202:203], v28 offset:52224
    buffer_load_dwordx4 a[188:191], v1, s[48:51], s71 offen offset:3072 sc1
    s_add_u32 s71, s82, 32768
    v_mfma_f32_32x32x16_bf16 v[64:79], v[220:223], a[140:143], v[64:79]
    s_waitcnt vmcnt(19) lgkmcnt(4)
    ds_read_b64_tr_b16 v[204:205], v27 offset:51200
    ds_read_b64_tr_b16 v[206:207], v27 offset:52224
    v_mfma_f32_32x32x16_bf16 v[80:95], v[192:195], a[144:147], v[80:95]
    s_waitcnt lgkmcnt(4)
    ds_read_b64_tr_b16 v[208:209], v28 offset:53248
    ds_read_b64_tr_b16 v[210:211], v28 offset:54272
    buffer_load_dwordx4 a[192:195], v1, s[48:51], s71 offen offset:0 sc1
    v_mfma_f32_32x32x16_bf16 v[64:79], v[196:199], a[144:147], v[64:79]
    s_waitcnt vmcnt(15) lgkmcnt(4)
    ds_read_b64_tr_b16 v[212:213], v27 offset:53248
    ds_read_b64_tr_b16 v[214:215], v27 offset:54272
    buffer_load_dwordx4 a[196:199], v1, s[48:51], s71 offen offset:1024 sc1
    v_mfma_f32_32x32x16_bf16 v[80:95], v[200:203], a[148:151], v[80:95]
    s_waitcnt lgkmcnt(4)
    ds_read_b64_tr_b16 v[216:217], v28 offset:55296
    ds_read_b64_tr_b16 v[218:219], v28 offset:56320
    v_mfma_f32_32x32x16_bf16 v[64:79], v[204:207], a[148:151], v[64:79]
    s_waitcnt vmcnt(15) lgkmcnt(4)
    ds_read_b64_tr_b16 v[220:221], v27 offset:55296
    ds_read_b64_tr_b16 v[222:223], v27 offset:56320
    buffer_load_dwordx4 a[200:203], v1, s[48:51], s71 offen offset:2048 sc1
    v_mfma_f32_32x32x16_bf16 v[80:95], v[208:211], a[152:155], v[80:95]
    s_waitcnt lgkmcnt(4)
    ds_read_b64_tr_b16 v[192:193], v30 offset:0
    ds_read_b64_tr_b16 v[194:195], v30 offset:1024
    buffer_load_dwordx4 a[204:207], v1, s[48:51], s71 offen offset:3072 sc1
    s_add_u32 s71, s82, 40960
    v_mfma_f32_32x32x16_bf16 v[64:79], v[212:215], a[152:155], v[64:79]
    s_waitcnt vmcnt(16) lgkmcnt(4)
    ds_read_b64_tr_b16 v[196:197], v29 offset:0
    ds_read_b64_tr_b16 v[198:199], v29 offset:1024
    v_mfma_f32_32x32x16_bf16 v[80:95], v[216:219], a[156:159], v[80:95]
    s_waitcnt lgkmcnt(4)
    ds_read_b64_tr_b16 v[200:201], v30 offset:2048
    ds_read_b64_tr_b16 v[202:203], v30 offset:3072
    buffer_load_dwordx4 a[208:211], v1, s[48:51], s71 offen offset:0 sc1
    v_mfma_f32_32x32x16_bf16 v[64:79], v[220:223], a[156:159], v[64:79]
    s_waitcnt vmcnt(16) lgkmcnt(4)
    ds_read_b64_tr_b16 v[204:205], v29 offset:2048
    ds_read_b64_tr_b16 v[206:207], v29 offset:3072
    buffer_load_dwordx4 a[212:215], v1, s[48:51], s71 offen offset:1024 sc1
    v_mfma_f32_32x32x16_bf16 v[80:95], v[192:195], a[160:163], v[80:95]
    s_waitcnt lgkmcnt(4)
    ds_read_b64_tr_b16 v[208:209], v30 offset:4096
    ds_read_b64_tr_b16 v[210:211], v30 offset:5120
    v_mfma_f32_32x32x16_bf16 v[64:79], v[196:199], a[160:163], v[64:79]
    s_waitcnt vmcnt(12) lgkmcnt(4)
    ds_read_b64_tr_b16 v[212:213], v29 offset:4096
    ds_read_b64_tr_b16 v[214:215], v29 offset:5120
    buffer_load_dwordx4 a[216:219], v1, s[48:51], s71 offen offset:2048 sc1
    v_mfma_f32_32x32x16_bf16 v[80:95], v[200:203], a[164:167], v[80:95]
    s_waitcnt lgkmcnt(4)
    ds_read_b64_tr_b16 v[216:217], v30 offset:6144
    ds_read_b64_tr_b16 v[218:219], v30 offset:7168
    buffer_load_dwordx4 a[220:223], v1, s[48:51], s71 offen offset:3072 sc1
    s_lshl_b32 s61, s15, 12
    s_add_u32 s61, s61, 4063232
    v_mfma_f32_32x32x16_bf16 v[64:79], v[204:207], a[164:167], v[64:79]
    s_waitcnt vmcnt(13) lgkmcnt(4)
    ds_read_b64_tr_b16 v[220:221], v29 offset:6144
    ds_read_b64_tr_b16 v[222:223], v29 offset:7168
    v_mfma_f32_32x32x16_bf16 v[80:95], v[208:211], a[168:171], v[80:95]
    s_waitcnt lgkmcnt(4)
    s_barrier
    ds_read_b64_tr_b16 v[192:193], v26 offset:0
    ds_read_b64_tr_b16 v[194:195], v26 offset:1024
    buffer_load_dwordx4 v[232:235], v1, s[48:51], s61 offen offset:0 sc1
    v_mfma_f32_32x32x16_bf16 v[64:79], v[212:215], a[168:171], v[64:79]
    s_waitcnt vmcnt(13) lgkmcnt(4)
    ds_read_b64_tr_b16 v[196:197], v25 offset:0
    ds_read_b64_tr_b16 v[198:199], v25 offset:1024
    buffer_load_dwordx4 v[236:239], v1, s[48:51], s61 offen offset:1024 sc1
    buffer_load_dwordx4 v[240:243], v1, s[48:51], s61 offen offset:2048 sc1
    v_mfma_f32_32x32x16_bf16 v[80:95], v[216:219], a[172:175], v[80:95]
    s_waitcnt lgkmcnt(4)
    ds_read_b64_tr_b16 v[200:201], v26 offset:2048
    ds_read_b64_tr_b16 v[202:203], v26 offset:3072
    buffer_load_dwordx4 v[244:247], v1, s[48:51], s61 offen offset:3072 sc1
    s_add_u32 s71, s82, 49152
    v_mfma_f32_32x32x16_bf16 v[64:79], v[220:223], a[172:175], v[64:79]
    s_waitcnt vmcnt(15) lgkmcnt(4)
    ds_read_b64_tr_b16 v[204:205], v25 offset:2048
    ds_read_b64_tr_b16 v[206:207], v25 offset:3072
    buffer_load_dwordx4 a[224:227], v1, s[48:51], s71 offen offset:0 sc1
    buffer_load_dwordx4 a[228:231], v1, s[48:51], s71 offen offset:1024 sc1
    v_mfma_f32_32x32x16_bf16 v[80:95], v[192:195], a[176:179], v[80:95]
    s_waitcnt lgkmcnt(4)
    ds_read_b64_tr_b16 v[208:209], v26 offset:4096
    ds_read_b64_tr_b16 v[210:211], v26 offset:5120
    buffer_load_dwordx4 a[232:235], v1, s[48:51], s71 offen offset:2048 sc1
    buffer_load_dwordx4 a[236:239], v1, s[48:51], s71 offen offset:3072 sc1
    v_mfma_f32_32x32x16_bf16 v[64:79], v[196:199], a[176:179], v[64:79]
    s_waitcnt vmcnt(18) lgkmcnt(4)
    ds_read_b64_tr_b16 v[212:213], v25 offset:4096
    ds_read_b64_tr_b16 v[214:215], v25 offset:5120
    v_mfma_f32_32x32x16_bf16 v[80:95], v[200:203], a[180:183], v[80:95]
    s_waitcnt lgkmcnt(4)
    ds_read_b64_tr_b16 v[216:217], v26 offset:6144
    ds_read_b64_tr_b16 v[218:219], v26 offset:7168
    v_mfma_f32_32x32x16_bf16 v[64:79], v[204:207], a[180:183], v[64:79]
    s_waitcnt vmcnt(17) lgkmcnt(4)
    ds_read_b64_tr_b16 v[220:221], v25 offset:6144
    ds_read_b64_tr_b16 v[222:223], v25 offset:7168
    v_mfma_f32_32x32x16_bf16 v[80:95], v[208:211], a[184:187], v[80:95]
    s_waitcnt lgkmcnt(4)
    ds_read_b64_tr_b16 v[192:193], v26 offset:16384
    ds_read_b64_tr_b16 v[194:195], v26 offset:17408
    v_mfma_f32_32x32x16_bf16 v[64:79], v[212:215], a[184:187], v[64:79]
    s_waitcnt vmcnt(16) lgkmcnt(4)
    ds_read_b64_tr_b16 v[196:197], v25 offset:16384
    ds_read_b64_tr_b16 v[198:199], v25 offset:17408
    v_mfma_f32_32x32x16_bf16 v[80:95], v[216:219], a[188:191], v[80:95]
    s_waitcnt lgkmcnt(4)
    ds_read_b64_tr_b16 v[200:201], v26 offset:18432
    ds_read_b64_tr_b16 v[202:203], v26 offset:19456
    v_mfma_f32_32x32x16_bf16 v[64:79], v[220:223], a[188:191], v[64:79]
    s_waitcnt vmcnt(15) lgkmcnt(4)
    ds_read_b64_tr_b16 v[204:205], v25 offset:18432
    ds_read_b64_tr_b16 v[206:207], v25 offset:19456
    v_mfma_f32_32x32x16_bf16 v[80:95], v[192:195], a[192:195], v[80:95]
    s_waitcnt lgkmcnt(4)
    ds_read_b64_tr_b16 v[208:209], v26 offset:20480
    ds_read_b64_tr_b16 v[210:211], v26 offset:21504
    v_mfma_f32_32x32x16_bf16 v[64:79], v[196:199], a[192:195], v[64:79]
    s_waitcnt vmcnt(14) lgkmcnt(4)
    ds_read_b64_tr_b16 v[212:213], v25 offset:20480
    ds_read_b64_tr_b16 v[214:215], v25 offset:21504
    v_mfma_f32_32x32x16_bf16 v[80:95], v[200:203], a[196:199], v[80:95]
    s_waitcnt lgkmcnt(4)
    ds_read_b64_tr_b16 v[216:217], v26 offset:22528
    ds_read_b64_tr_b16 v[218:219], v26 offset:23552
    v_mfma_f32_32x32x16_bf16 v[64:79], v[204:207], a[196:199], v[64:79]
    s_waitcnt vmcnt(13) lgkmcnt(4)
    ds_read_b64_tr_b16 v[220:221], v25 offset:22528
    ds_read_b64_tr_b16 v[222:223], v25 offset:23552
    v_mfma_f32_32x32x16_bf16 v[80:95], v[208:211], a[200:203], v[80:95]
    s_waitcnt lgkmcnt(4)
    ds_read_b64_tr_b16 v[192:193], v26 offset:32768
    ds_read_b64_tr_b16 v[194:195], v26 offset:33792
    v_mfma_f32_32x32x16_bf16 v[64:79], v[212:215], a[200:203], v[64:79]
    s_waitcnt vmcnt(12) lgkmcnt(4)
    ds_read_b64_tr_b16 v[196:197], v26 offset:34816
    ds_read_b64_tr_b16 v[198:199], v26 offset:35840
    v_mfma_f32_32x32x16_bf16 v[80:95], v[216:219], a[204:207], v[80:95]
    s_waitcnt lgkmcnt(4)
    ds_read_b64_tr_b16 v[200:201], v26 offset:36864
    ds_read_b64_tr_b16 v[202:203], v26 offset:37888
    v_mfma_f32_32x32x16_bf16 v[64:79], v[220:223], a[204:207], v[64:79]
    s_waitcnt vmcnt(11) lgkmcnt(4)
    ds_read_b64_tr_b16 v[204:205], v26 offset:38912
    ds_read_b64_tr_b16 v[206:207], v26 offset:39936
    v_mfma_f32_32x32x16_bf16 v[80:95], v[192:195], a[208:211], v[80:95]
    s_waitcnt vmcnt(10) lgkmcnt(4)
    ds_read_b64_tr_b16 v[208:209], v26 offset:49152
    ds_read_b64_tr_b16 v[210:211], v26 offset:50176
    s_add_u32 s63, s13, 147456
    v_add_u32 v52, s63, v1
    v_xor_b32 v53, 0x2000, v52
    v_and_b32 v54, 31, v0
    v_mfma_f32_32x32x16_bf16 v[80:95], v[196:199], a[212:215], v[80:95]
    s_waitcnt vmcnt(9) lgkmcnt(4)
    ds_read_b64_tr_b16 v[212:213], v26 offset:51200
    ds_read_b64_tr_b16 v[214:215], v26 offset:52224
    v_lshrrev_b32 v55, 5, v0
    v_lshlrev_b32 v54, 10, v54
    v_lshl_add_u32 v54, v55, 4, v54
    s_waitcnt vmcnt(4)
    v_mfma_f32_32x32x16_bf16 v[80:95], v[200:203], a[216:219], v[80:95]
    s_waitcnt lgkmcnt(4)
    ds_read_b64_tr_b16 v[216:217], v26 offset:53248
    ds_read_b64_tr_b16 v[218:219], v26 offset:54272
    v_add_f32 v232, v232, v233
    v_add_f32 v240, v240, v241
    v_add_f32 v234, v234, v235
    v_add_f32 v242, v242, v243
    v_mfma_f32_32x32x16_bf16 v[80:95], v[204:207], a[220:223], v[80:95]
    s_waitcnt vmcnt(3) lgkmcnt(4)
    ds_read_b64_tr_b16 v[220:221], v26 offset:55296
    ds_read_b64_tr_b16 v[222:223], v26 offset:56320
    v_add_f32 v236, v236, v237
    v_add_f32 v244, v244, v245
    v_add_f32 v238, v238, v239
    v_add_f32 v246, v246, v247
    v_mfma_f32_32x32x16_bf16 v[80:95], v[208:211], a[224:227], v[80:95]
    s_waitcnt vmcnt(2) lgkmcnt(4)
    ds_read_b64_tr_b16 v[192:193], v25 offset:32768
    ds_read_b64_tr_b16 v[194:195], v25 offset:33792
    v_add_f32 v232, v232, v236
    v_add_f32 v240, v240, v244
    v_add_f32 v234, v234, v238
    v_add_f32 v242, v242, v246
    v_mfma_f32_32x32x16_bf16 v[80:95], v[212:215], a[228:231], v[80:95]
    s_waitcnt vmcnt(1) lgkmcnt(4)
    ds_read_b64_tr_b16 v[196:197], v25 offset:34816
    ds_read_b64_tr_b16 v[198:199], v25 offset:35840
    v_permlane16_swap_b32 v232, v234
    v_permlane16_swap_b32 v240, v242
    v_mfma_f32_32x32x16_bf16 v[80:95], v[216:219], a[232:235], v[80:95]
    s_waitcnt vmcnt(0) lgkmcnt(4)
    ds_read_b64_tr_b16 v[200:201], v25 offset:36864
    ds_read_b64_tr_b16 v[202:203], v25 offset:37888
    v_add_f32 v232, v232, v234
    v_add_f32 v240, v240, v242
    v_mov_b32 v234, v232
    v_mov_b32 v242, v240
    v_mfma_f32_32x32x16_bf16 v[80:95], v[220:223], a[236:239], v[80:95]
    s_waitcnt lgkmcnt(4)
    ds_read_b64_tr_b16 v[204:205], v25 offset:38912
    ds_read_b64_tr_b16 v[206:207], v25 offset:39936
    v_permlane32_swap_b32 v232, v234
    v_permlane32_swap_b32 v240, v242
    v_mfma_f32_32x32x16_bf16 v[64:79], v[192:195], a[208:211], v[64:79]
    s_waitcnt lgkmcnt(4)
    ds_read_b64_tr_b16 v[208:209], v25 offset:49152
    ds_read_b64_tr_b16 v[210:211], v25 offset:50176
    v_add_f32 v232, v232, v234
    v_add_f32 v240, v240, v242
    v_mul_f32 v252, s67, v232
    v_mul_f32 v253, s67, v240
    v_mfma_f32_32x32x16_bf16 v[64:79], v[196:199], a[212:215], v[64:79]
    s_waitcnt lgkmcnt(4)
    ds_read_b64_tr_b16 v[212:213], v25 offset:51200
    ds_read_b64_tr_b16 v[214:215], v25 offset:52224
    v_fma_f32 v253, -v252, v252, v253
    v_max_f32 v253, 0, v253
    v_add_f32 v253, s68, v253
    v_rcp_f32 v252, v253
    v_mfma_f32_32x32x16_bf16 v[64:79], v[200:203], a[216:219], v[64:79]
    s_waitcnt lgkmcnt(4)
    ds_read_b64_tr_b16 v[216:217], v25 offset:53248
    ds_read_b64_tr_b16 v[218:219], v25 offset:54272
    ds_write_b128 v52, v[80:83] offset:0
    v_mfma_f32_32x32x16_bf16 v[64:79], v[204:207], a[220:223], v[64:79]
    s_waitcnt lgkmcnt(5)
    ds_read_b64_tr_b16 v[220:221], v25 offset:55296
    ds_read_b64_tr_b16 v[222:223], v25 offset:56320
    ds_write_b128 v52, v[84:87] offset:1024
    v_mfma_f32_32x32x16_bf16 v[64:79], v[208:211], a[224:227], v[64:79]
    s_waitcnt lgkmcnt(6)
    ds_write_b128 v52, v[88:91] offset:2048
    v_mfma_f32_32x32x16_bf16 v[64:79], v[212:215], a[228:231], v[64:79]
    s_waitcnt lgkmcnt(5)
    ds_write_b128 v52, v[92:95] offset:3072
    v_mfma_f32_32x32x16_bf16 v[64:79], v[216:219], a[232:235], v[64:79]
    s_waitcnt lgkmcnt(3)
    s_waitcnt lgkmcnt(0)
    s_barrier
    ds_read_b128 v[96:99], v53 offset:0
    ds_read_b128 v[100:103], v53 offset:1024
    ds_read_b128 v[104:107], v53 offset:2048
    ds_read_b128 v[108:111], v53 offset:3072
    v_mfma_f32_32x32x16_bf16 v[64:79], v[220:223], a[236:239], v[64:79]
    s_waitcnt lgkmcnt(2)
    s_nop 10
    v_pk_add_f32 v[64:65], v[64:65], v[96:97]
    v_pk_add_f32 v[66:67], v[66:67], v[98:99]
    v_pk_add_f32 v[68:69], v[68:69], v[100:101]
    v_pk_add_f32 v[70:71], v[70:71], v[102:103]
    v_pk_fma_f32 v[64:65], v[64:65], v[252:253], v[32:33] op_sel_hi:[1,0,1]
    v_pk_fma_f32 v[66:67], v[66:67], v[252:253], v[34:35] op_sel_hi:[1,0,1]
    v_pk_fma_f32 v[68:69], v[68:69], v[252:253], v[36:37] op_sel_hi:[1,0,1]
    v_pk_fma_f32 v[70:71], v[70:71], v[252:253], v[38:39] op_sel_hi:[1,0,1]
    v_cvt_pk_bf16_f32 v112, v64, v65
    v_cvt_pk_bf16_f32 v113, v66, v67
    v_cvt_pk_bf16_f32 v114, v68, v69
    v_cvt_pk_bf16_f32 v115, v70, v71
    s_nop 0
    v_permlane32_swap_b32 v112, v114
    v_permlane32_swap_b32 v113, v115
    buffer_store_dwordx4 v[112:115], v54, s[44:47], s20 offen offset:0
    s_waitcnt lgkmcnt(0)
    v_pk_add_f32 v[72:73], v[72:73], v[104:105]
    v_pk_add_f32 v[74:75], v[74:75], v[106:107]
    v_pk_add_f32 v[76:77], v[76:77], v[108:109]
    v_pk_add_f32 v[78:79], v[78:79], v[110:111]
    v_pk_fma_f32 v[72:73], v[72:73], v[252:253], v[40:41] op_sel_hi:[1,0,1]
    v_pk_fma_f32 v[74:75], v[74:75], v[252:253], v[42:43] op_sel_hi:[1,0,1]
    v_pk_fma_f32 v[76:77], v[76:77], v[252:253], v[44:45] op_sel_hi:[1,0,1]
    v_pk_fma_f32 v[78:79], v[78:79], v[252:253], v[46:47] op_sel_hi:[1,0,1]
    v_cvt_pk_bf16_f32 v116, v72, v73
    v_cvt_pk_bf16_f32 v117, v74, v75
    v_cvt_pk_bf16_f32 v118, v76, v77
    v_cvt_pk_bf16_f32 v119, v78, v79
    s_nop 0
    v_permlane32_swap_b32 v116, v118
    v_permlane32_swap_b32 v117, v119
    buffer_store_dwordx4 v[116:119], v54, s[44:47], s20 offen offset:32
    s_endpgm
L_spare:
    s_waitcnt lgkmcnt(0)
    s_barrier
    s_cmp_lt_u32 s5, 28
    s_cbranch_scc1 L_sw29
    s_sub_u32 s63, s95, 896
    s_mul_i32 s63, s63, 14336
    v_lshlrev_b32 v50, 7, v0
    v_min_u32 v51, 6016, v50
    buffer_load_dword v49, v50, s[40:43], s63 offen
    s_add_u32 s63, s63, 8192
    buffer_load_dword v49, v51, s[40:43], s63 offen
L_sw29:
    s_cmp_lg_u32 s2, 248
    s_cbranch_scc1 L_ne30
    s_cmp_lg_u32 s3, 0
    s_cbranch_scc1 L_ne30
    v_and_b32 v52, 3, v0
    v_bfe_u32 v53, v0, 2, 3
    v_lshlrev_b32 v52, 8, v52
    v_lshl_add_u32 v52, v53, 11, v52
    v_lshrrev_b32 v53, 5, v0
    v_lshl_add_u32 v52, v53, 21, v52
    v_add_u32 v52, 4096000, v52
    s_mov_b32 s60, 0
L_poll31:
    buffer_load_dword v50, v52, s[48:51], 0 offen sc1
    s_add_u32 s60, s60, 1
    s_cmp_gt_u32 s60, 262144
    s_waitcnt vmcnt(0)
    s_cbranch_scc1 L_pollx32
    v_xor_b32 v51, v50, v48
    v_cmp_lt_u32 vcc, 15, v51
    s_nop 1
    s_cbranch_vccnz L_poll31
L_pollx32:
    v_and_b32 v52, 3, v0
    v_bfe_u32 v53, v0, 2, 3
    v_lshlrev_b32 v52, 8, v52
    v_lshl_add_u32 v52, v53, 11, v52
    v_lshrrev_b32 v53, 5, v0
    v_lshl_add_u32 v52, v53, 21, v52
    v_add_u32 v52, 8290304, v52
    s_mov_b32 s60, 0
L_poll33:
    buffer_load_dword v50, v52, s[48:51], 0 offen sc1
    s_add_u32 s60, s60, 1
    s_cmp_gt_u32 s60, 262144
    s_waitcnt vmcnt(0)
    s_cbranch_scc1 L_pollx34
    v_xor_b32 v51, v50, v48
    v_cmp_lt_u32 vcc, 15, v51
    s_nop 1
    s_cbranch_vccnz L_poll33
L_pollx34:
    v_and_b32 v52, 3, v0
    v_bfe_u32 v53, v0, 2, 3
    v_lshlrev_b32 v52, 8, v52
    v_lshl_add_u32 v52, v53, 11, v52
    v_lshrrev_b32 v53, 5, v0
    v_lshl_add_u32 v52, v53, 21, v52
    v_add_u32 v52, 12484608, v52
    s_mov_b32 s60, 0
L_poll35:
    buffer_load_dword v50, v52, s[48:51], 0 offen sc1
    s_add_u32 s60, s60, 1
    s_cmp_gt_u32 s60, 262144
    s_waitcnt vmcnt(0)
    s_cbranch_scc1 L_pollx36
    v_xor_b32 v51, v50, v48
    v_cmp_lt_u32 vcc, 15, v51
    s_nop 1
    s_cbranch_vccnz L_poll35
L_pollx36:
    v_and_b32 v52, 3, v0
    v_bfe_u32 v53, v0, 2, 3
    v_lshlrev_b32 v52, 8, v52
    v_lshl_add_u32 v52, v53, 11, v52
    v_lshrrev_b32 v53, 5, v0
    v_lshl_add_u32 v52, v53, 21, v52
    v_add_u32 v52, 16678912, v52
    s_mov_b32 s60, 0
L_poll37:
    buffer_load_dword v50, v52, s[48:51], 0 offen sc1
    s_add_u32 s60, s60, 1
    s_cmp_gt_u32 s60, 262144
    s_waitcnt vmcnt(0)
    s_cbranch_scc1 L_pollx38
    v_xor_b32 v51, v50, v48
    v_cmp_lt_u32 vcc, 15, v51
    s_nop 1
    s_cbranch_vccnz L_poll37
L_pollx38:
    s_mov_b32 s63, 0
    buffer_store_dword v48, off, s[48:51], s63 sc1
L_ne30:
    s_add_u32 s62, s23, 0
    s_add_u32 m0, s13, 131072
    s_nop 0
    buffer_load_dwordx4 v10, s[40:43], s62 offen offset:0 lds
    buffer_load_dwordx4 v11, s[40:43], s62 offen offset:1024 lds
    buffer_load_dwordx4 v12, s[40:43], s62 offen offset:2048 lds
    buffer_load_dwordx4 v13, s[40:43], s62 offen offset:3072 lds
    s_add_u32 s62, s23, 131072
    s_add_u32 m0, s13, 0
    s_nop 0
    buffer_load_dwordx4 v10, s[40:43], s62 offen offset:0 lds
    buffer_load_dwordx4 v11, s[40:43], s62 offen offset:1024 lds
    buffer_load_dwordx4 v12, s[40:43], s62 offen offset:2048 lds
    buffer_load_dwordx4 v13, s[40:43], s62 offen offset:3072 lds
    s_add_u32 s62, s23, 262144
    s_add_u32 m0, s13, 16384
    s_nop 0
    buffer_load_dwordx4 v10, s[40:43], s62 offen offset:0 lds
    buffer_load_dwordx4 v11, s[40:43], s62 offen offset:1024 lds
    buffer_load_dwordx4 v12, s[40:43], s62 offen offset:2048 lds
    buffer_load_dwordx4 v13, s[40:43], s62 offen offset:3072 lds
    s_add_u32 s62, s23, 393216
    s_add_u32 m0, s13, 32768
    s_nop 0
    buffer_load_dwordx4 v10, s[40:43], s62 offen offset:0 lds
    buffer_load_dwordx4 v11, s[40:43], s62 offen offset:1024 lds
    buffer_load_dwordx4 v12, s[40:43], s62 offen offset:2048 lds
    buffer_load_dwordx4 v13, s[40:43], s62 offen offset:3072 lds
    s_add_u32 s62, s23, 524288
    s_add_u32 m0, s13, 49152
    s_nop 0
    buffer_load_dwordx4 v10, s[40:43], s62 offen offset:0 lds
    buffer_load_dwordx4 v11, s[40:43], s62 offen offset:1024 lds
    buffer_load_dwordx4 v12, s[40:43], s62 offen offset:2048 lds
    buffer_load_dwordx4 v13, s[40:43], s62 offen offset:3072 lds
    s_add_u32 s62, s23, 655360
    s_add_u32 m0, s13, 65536
    s_nop 0
    buffer_load_dwordx4 v10, s[40:43], s62 offen offset:0 lds
    buffer_load_dwordx4 v11, s[40:43], s62 offen offset:1024 lds
    buffer_load_dwordx4 v12, s[40:43], s62 offen offset:2048 lds
    buffer_load_dwordx4 v13, s[40:43], s62 offen offset:3072 lds
    s_add_u32 s62, s23, 786432
    s_add_u32 m0, s13, 81920
    s_nop 0
    buffer_load_dwordx4 v10, s[40:43], s62 offen offset:0 lds
    buffer_load_dwordx4 v11, s[40:43], s62 offen offset:1024 lds
    buffer_load_dwordx4 v12, s[40:43], s62 offen offset:2048 lds
    buffer_load_dwordx4 v13, s[40:43], s62 offen offset:3072 lds
    s_add_u32 s62, s80, 0
    s_add_u32 m0, s13, 98304
    s_nop 0
    buffer_load_dwordx4 v10, s[40:43], s62 offen offset:0 lds
    buffer_load_dwordx4 v11, s[40:43], s62 offen offset:1024 lds
    buffer_load_dwordx4 v12, s[40:43], s62 offen offset:2048 lds
    buffer_load_dwordx4 v13, s[40:43], s62 offen offset:3072 lds
    s_mov_b32 s60, 0
L_poll39:
    buffer_load_dword v50, v57, s[48:51], 0 offen sc1
    s_add_u32 s60, s60, 1
    s_cmp_gt_u32 s60, 262144
    s_waitcnt vmcnt(0)
    s_cbranch_scc1 L_pollx40
    v_xor_b32 v51, v50, v48
    v_cmp_lt_u32 vcc, 15, v51
    s_nop 1
    s_cbranch_vccnz L_poll39
L_pollx40:
    s_cmp_lg_u32 s10, 0
    s_cbranch_scc1 L_aq41
    buffer_inv sc1
    s_waitcnt vmcnt(0)
L_aq41:
    s_add_u32 s70, s81, 0
    buffer_load_dwordx4 a[0:3], v1, s[48:51], s70 offen offset:0 sc1
    buffer_load_dwordx4 a[4:7], v1, s[48:51], s70 offen offset:1024 sc1
    buffer_load_dwordx4 a[8:11], v1, s[48:51], s70 offen offset:2048 sc1
    buffer_load_dwordx4 a[12:15], v1, s[48:51], s70 offen offset:3072 sc1
    s_add_u32 s70, s81, 8192
    buffer_load_dwordx4 a[16:19], v1, s[48:51], s70 offen offset:0 sc1
    buffer_load_dwordx4 a[20:23], v1, s[48:51], s70 offen offset:1024 sc1
    buffer_load_dwordx4 a[24:27], v1, s[48:51], s70 offen offset:2048 sc1
    buffer_load_dwordx4 a[28:31], v1, s[48:51], s70 offen offset:3072 sc1
    s_waitcnt vmcnt(0)
    s_branch L_down
L_spin2:
    s_mov_b32 s60, 0
L_poll42:
    buffer_load_dword v50, v61, s[48:51], 0 offen sc1
    s_add_u32 s60, s60, 1
    s_cmp_gt_u32 s60, 262144
    s_waitcnt vmcnt(0)
    s_cbranch_scc1 L_pollx43
    v_xor_b32 v51, v50, v48
    v_cmp_lt_u32 vcc, 15, v51
    s_nop 1
    s_cbranch_vccnz L_poll42
L_pollx43:
    v_mov_b32 v72, v50
    s_branch L_back3
L_spin8:
    s_mov_b32 s60, 0
L_poll44:
    buffer_load_dword v50, v63, s[48:51], 0 offen sc1
    s_add_u32 s60, s60, 1
    s_cmp_gt_u32 s60, 262144
    s_waitcnt vmcnt(0)
    s_cbranch_scc1 L_pollx45
    v_xor_b32 v51, v50, v48
    v_cmp_lt_u32 vcc, 15, v51
    s_nop 1
    s_cbranch_vccnz L_poll44
L_pollx45:
    v_mov_b32 v72, v50
    s_branch L_back9
L_spin22:
    s_mov_b32 s60, 0
L_poll46:
    buffer_load_dword v50, v57, s[48:51], 0 offen sc1
    s_add_u32 s60, s60, 1
    s_cmp_gt_u32 s60, 262144
    s_waitcnt vmcnt(0)
    s_cbranch_scc1 L_pollx47
    v_xor_b32 v51, v50, v48
    v_cmp_lt_u32 vcc, 15, v51
    s_nop 1
    s_cbranch_vccnz L_poll46
L_pollx47:
    s_cmp_lg_u32 s10, 0
    s_cbranch_scc1 L_aq48
    buffer_inv sc1
    s_waitcnt vmcnt(0)
L_aq48:
    s_branch L_back23
L_spin27:
    s_mov_b32 s60, 0
L_poll49:
    buffer_load_dword v50, v58, s[48:51], 0 offen sc1
    s_add_u32 s60, s60, 1
    s_cmp_gt_u32 s60, 262144
    s_waitcnt vmcnt(0)
    s_cbranch_scc1 L_pollx50
    v_xor_b32 v51, v50, v48
    v_cmp_lt_u32 vcc, 15, v51
    s_nop 1
    s_cbranch_vccnz L_poll49
L_pollx50:
    s_cmp_lg_u32 s10, 0
    s_cbranch_scc1 L_aq51
    buffer_inv sc1
    s_waitcnt vmcnt(0)
L_aq51:
    s_branch L_back28
L_truemax:
    s_waitcnt vmcnt(0)
    s_mov_b32 s90, 1
    v_mov_b32 v212, 1065369472
    v_mov_b32 v213, 1065369472
    v_mov_b32 v214, 1065369472
    v_mov_b32 v215, 1065369472
    v_mov_b32 v216, 1065369472
    v_mov_b32 v217, 1065369472
    v_mov_b32 v218, 1065369472
    v_mov_b32 v219, 1065369472
    v_mov_b32 v220, 4286578688
    s_lshl_b32 s73, s8, 1
    s_sub_i32 s73, 8, s73
    s_max_i32 s73, s73, 0
L_tm00:
    s_add_u32 s71, s73, 0
    s_lshl1_add_u32 s63, s6, s71
    s_lshl_b32 s71, s71, 11
    s_add_u32 s71, s71, s70
    s_cmp_ge_u32 s63, 8
    s_cselect_b32 s63, 2080768, 0
    s_add_u32 s71, s71, s63
    buffer_load_dwordx4 v[208:211], v1, s[48:51], s71 offen sc1
    s_waitcnt vmcnt(0)
    s_cmp_eq_u32 s73, 0
    s_cbranch_scc1 L_tm00f
    s_cmp_eq_u32 s73, 8
    s_cbranch_scc1 L_tm00d
    v_mfma_f32_32x32x16_bf16 v[96:111], v[208:211], a[248:251], 0
    s_branch L_tm00x
L_tm00f:
    v_mfma_f32_32x32x16_bf16 v[96:111], v[208:211], a[248:251], v[192:207]
    s_branch L_tm00x
L_tm00d:
    v_mfma_f32_32x32x16_bf16 v[96:111], v[208:211], a[248:251], v[176:191]
L_tm00x:
    s_nop 15
    v_max3_f32 v220, v96, v97, v220
    v_max3_f32 v220, v98, v99, v220
    v_max3_f32 v220, v100, v101, v220
    v_max3_f32 v220, v102, v103, v220
    v_max3_f32 v220, v104, v105, v220
    v_max3_f32 v220, v106, v107, v220
    v_max3_f32 v220, v108, v109, v220
    v_max3_f32 v220, v110, v111, v220
    s_add_u32 s73, s73, 1
    s_cmp_le_u32 s73, 8
    s_cbranch_scc1 L_tm00
    v_mov_b32 v221, v220
    s_nop 1
    v_permlane32_swap_b32 v220, v221
    v_max_f32 v220, v220, v221
    v_mov_b32 v144, 0
    v_mov_b32 v145, 0
    v_mov_b32 v146, 0
    v_mov_b32 v147, 0
    v_mov_b32 v148, 0
    v_mov_b32 v149, 0
    v_mov_b32 v150, 0
    v_mov_b32 v151, 0
    v_mov_b32 v152, 0
    v_mov_b32 v153, 0
    v_mov_b32 v154, 0
    v_mov_b32 v155, 0
    v_mov_b32 v156, 0
    v_mov_b32 v157, 0
    v_mov_b32 v158, 0
    v_mov_b32 v159, 0
    s_lshl_b32 s73, s8, 1
    s_sub_i32 s73, 8, s73
    s_max_i32 s73, s73, 0
L_tm01:
    s_add_u32 s71, s73, 0
    s_lshl1_add_u32 s63, s6, s71
    s_lshl_b32 s71, s71, 11
    s_add_u32 s71, s71, s70
    s_cmp_ge_u32 s63, 8
    s_cselect_b32 s63, 2080768, 0
    s_add_u32 s71, s71, s63
    buffer_load_dwordx4 v[208:211], v1, s[48:51], s71 offen sc1
    s_mov_b32 exec_lo, 0xffff
    s_mov_b32 exec_hi, 0xffff
    buffer_load_dwordx4 v[212:215], v60, s[48:51], s71 offen offset:1024 sc1
    buffer_load_dwordx4 v[216:219], v60, s[48:51], s71 offen offset:1536 sc1
    s_mov_b64 exec, -1
    s_waitcnt vmcnt(0)
    s_cmp_eq_u32 s73, 0
    s_cbranch_scc1 L_tm01f
    s_cmp_eq_u32 s73, 8
    s_cbranch_scc1 L_tm01d
    v_mfma_f32_32x32x16_bf16 v[96:111], v[208:211], a[248:251], 0
    s_branch L_tm01x
L_tm01f:
    v_mfma_f32_32x32x16_bf16 v[96:111], v[208:211], a[248:251], v[192:207]
    s_branch L_tm01x
L_tm01d:
    v_mfma_f32_32x32x16_bf16 v[96:111], v[208:211], a[248:251], v[176:191]
L_tm01x:
    s_nop 15
    v_sub_f32 v96, v96, v220
    v_sub_f32 v97, v97, v220
    v_sub_f32 v98, v98, v220
    v_sub_f32 v99, v99, v220
    v_sub_f32 v100, v100, v220
    v_sub_f32 v101, v101, v220
    v_sub_f32 v102, v102, v220
    v_sub_f32 v103, v103, v220
    v_sub_f32 v104, v104, v220
    v_sub_f32 v105, v105, v220
    v_sub_f32 v106, v106, v220
    v_sub_f32 v107, v107, v220
    v_sub_f32 v108, v108, v220
    v_sub_f32 v109, v109, v220
    v_sub_f32 v110, v110, v220
    v_sub_f32 v111, v111, v220
    v_exp_f32 v96, v96
    v_exp_f32 v97, v97
    v_exp_f32 v98, v98
    v_exp_f32 v99, v99
    v_exp_f32 v100, v100
    v_exp_f32 v101, v101
    v_exp_f32 v102, v102
    v_exp_f32 v103, v103
    v_exp_f32 v104, v104
    v_exp_f32 v105, v105
    v_exp_f32 v106, v106
    v_exp_f32 v107, v107
    v_exp_f32 v108, v108
    v_exp_f32 v109, v109
    v_exp_f32 v110, v110
    v_exp_f32 v111, v111
    v_cvt_pk_bf16_f32 v128, v96, v97
    v_cvt_pk_bf16_f32 v129, v98, v99
    v_cvt_pk_bf16_f32 v130, v100, v101
    v_cvt_pk_bf16_f32 v131, v102, v103
    v_cvt_pk_bf16_f32 v132, v104, v105
    v_cvt_pk_bf16_f32 v133, v106, v107
    v_cvt_pk_bf16_f32 v134, v108, v109
    v_cvt_pk_bf16_f32 v135, v110, v111
    v_mfma_f32_32x32x16_bf16 v[144:159], v[212:215], v[128:131], v[144:159]
    s_nop 0
    v_mfma_f32_32x32x16_bf16 v[144:159], v[216:219], v[132:135], v[144:159]
    s_nop 15
    s_add_u32 s73, s73, 1
    s_cmp_le_u32 s73, 8
    s_cbranch_scc1 L_tm01
    v_mov_b32 v220, 4286578688
    s_lshl_b32 s73, s8, 1
    s_sub_i32 s73, 7, s73
    s_max_i32 s73, s73, 0
L_tm10:
    s_add_u32 s71, s73, 1
    s_lshl1_add_u32 s63, s6, s71
    s_lshl_b32 s71, s71, 11
    s_add_u32 s71, s71, s70
    s_cmp_ge_u32 s63, 8
    s_cselect_b32 s63, 2080768, 0
    s_add_u32 s71, s71, s63
    buffer_load_dwordx4 v[208:211], v1, s[48:51], s71 offen sc1
    s_waitcnt vmcnt(0)
    s_cmp_eq_u32 s73, 0
    s_cbranch_scc1 L_tm10f
    s_cmp_eq_u32 s73, 8
    s_cbranch_scc1 L_tm10d
    v_mfma_f32_32x32x16_bf16 v[96:111], v[208:211], a[252:255], 0
    s_branch L_tm10x
L_tm10f:
    v_mfma_f32_32x32x16_bf16 v[96:111], v[208:211], a[252:255], v[192:207]
    s_branch L_tm10x
L_tm10d:
    v_mfma_f32_32x32x16_bf16 v[96:111], v[208:211], a[252:255], v[176:191]
L_tm10x:
    s_nop 15
    v_max3_f32 v220, v96, v97, v220
    v_max3_f32 v220, v98, v99, v220
    v_max3_f32 v220, v100, v101, v220
    v_max3_f32 v220, v102, v103, v220
    v_max3_f32 v220, v104, v105, v220
    v_max3_f32 v220, v106, v107, v220
    v_max3_f32 v220, v108, v109, v220
    v_max3_f32 v220, v110, v111, v220
    s_add_u32 s73, s73, 1
    s_cmp_le_u32 s73, 8
    s_cbranch_scc1 L_tm10
    v_mov_b32 v221, v220
    s_nop 1
    v_permlane32_swap_b32 v220, v221
    v_max_f32 v220, v220, v221
    v_mov_b32 v160, 0
    v_mov_b32 v161, 0
    v_mov_b32 v162, 0
    v_mov_b32 v163, 0
    v_mov_b32 v164, 0
    v_mov_b32 v165, 0
    v_mov_b32 v166, 0
    v_mov_b32 v167, 0
    v_mov_b32 v168, 0
    v_mov_b32 v169, 0
    v_mov_b32 v170, 0
    v_mov_b32 v171, 0
    v_mov_b32 v172, 0
    v_mov_b32 v173, 0
    v_mov_b32 v174, 0
    v_mov_b32 v175, 0
    s_lshl_b32 s73, s8, 1
    s_sub_i32 s73, 7, s73
    s_max_i32 s73, s73, 0
L_tm11:
    s_add_u32 s71, s73, 1
    s_lshl1_add_u32 s63, s6, s71
    s_lshl_b32 s71, s71, 11
    s_add_u32 s71, s71, s70
    s_cmp_ge_u32 s63, 8
    s_cselect_b32 s63, 2080768, 0
    s_add_u32 s71, s71, s63
    buffer_load_dwordx4 v[208:211], v1, s[48:51], s71 offen sc1
    s_mov_b32 exec_lo, 0xffff
    s_mov_b32 exec_hi, 0xffff
    buffer_load_dwordx4 v[212:215], v60, s[48:51], s71 offen offset:1024 sc1
    buffer_load_dwordx4 v[216:219], v60, s[48:51], s71 offen offset:1536 sc1
    s_mov_b64 exec, -1
    s_waitcnt vmcnt(0)
    s_cmp_eq_u32 s73, 0
    s_cbranch_scc1 L_tm11f
    s_cmp_eq_u32 s73, 8
    s_cbranch_scc1 L_tm11d
    v_mfma_f32_32x32x16_bf16 v[96:111], v[208:211], a[252:255], 0
    s_branch L_tm11x
L_tm11f:
    v_mfma_f32_32x32x16_bf16 v[96:111], v[208:211], a[252:255], v[192:207]
    s_branch L_tm11x
L_tm11d:
    v_mfma_f32_32x32x16_bf16 v[96:111], v[208:211], a[252:255], v[176:191]
L_tm11x:
    s_nop 15
    v_sub_f32 v96, v96, v220
    v_sub_f32 v97, v97, v220
    v_sub_f32 v98, v98, v220
    v_sub_f32 v99, v99, v220
    v_sub_f32 v100, v100, v220
    v_sub_f32 v101, v101, v220
    v_sub_f32 v102, v102, v220
    v_sub_f32 v103, v103, v220
    v_sub_f32 v104, v104, v220
    v_sub_f32 v105, v105, v220
    v_sub_f32 v106, v106, v220
    v_sub_f32 v107, v107, v220
    v_sub_f32 v108, v108, v220
    v_sub_f32 v109, v109, v220
    v_sub_f32 v110, v110, v220
    v_sub_f32 v111, v111, v220
    v_exp_f32 v96, v96
    v_exp_f32 v97, v97
    v_exp_f32 v98, v98
    v_exp_f32 v99, v99
    v_exp_f32 v100, v100
    v_exp_f32 v101, v101
    v_exp_f32 v102, v102
    v_exp_f32 v103, v103
    v_exp_f32 v104, v104
    v_exp_f32 v105, v105
    v_exp_f32 v106, v106
    v_exp_f32 v107, v107
    v_exp_f32 v108, v108
    v_exp_f32 v109, v109
    v_exp_f32 v110, v110
    v_exp_f32 v111, v111
    v_cvt_pk_bf16_f32 v128, v96, v97
    v_cvt_pk_bf16_f32 v129, v98, v99
    v_cvt_pk_bf16_f32 v130, v100, v101
    v_cvt_pk_bf16_f32 v131, v102, v103
    v_cvt_pk_bf16_f32 v132, v104, v105
    v_cvt_pk_bf16_f32 v133, v106, v107
    v_cvt_pk_bf16_f32 v134, v108, v109
    v_cvt_pk_bf16_f32 v135, v110, v111
    v_mfma_f32_32x32x16_bf16 v[160:175], v[212:215], v[128:131], v[160:175]
    s_nop 0
    v_mfma_f32_32x32x16_bf16 v[160:175], v[216:219], v[132:135], v[160:175]
    s_nop 15
    s_add_u32 s73, s73, 1
    s_cmp_le_u32 s73, 8
    s_cbranch_scc1 L_tm11
    s_branch L_onorm
L_exit:
    s_endpgm
.fill 2560, 4, 0xbf800000
.section .rodata,"a"
.p2align 6
.amdhsa_kernel sequential_preLN__sliding_block__glu_gated_bilinear__prompt_kernel
  .amdhsa_next_free_vgpr 512
  .amdhsa_next_free_sgpr 102
  .amdhsa_accum_offset 256
  .amdhsa_group_segment_fixed_size 0
  .amdhsa_kernarg_size 80
  .amdhsa_user_sgpr_count 2
  .amdhsa_user_sgpr_kernarg_segment_ptr 1
  .amdhsa_system_sgpr_workgroup_id_x 1
.end_amdhsa_kernel
```
